```python
import torch

def _softmax(x, axis=-1):
    return torch.softmax(x, dim=axis)
def _gelu(x):
    return torch.nn.functional.gelu(x, approximate="tanh")
def _silu(x):
    return torch.nn.functional.silu(x)
def _sigmoid(x):
    return torch.sigmoid(x)
def _layernorm(x, axis=-1, eps=1e-5):
    m = x.mean(dim=axis, keepdim=True)
    v = x.var(dim=axis, keepdim=True, unbiased=False)
    return (x - m) / torch.sqrt(v + eps)
def _scatter_add(tgt, idx, src, axis=0):
    return tgt.clone().index_add_(axis, idx, src)
def _segment_sum(src, seg, n):
    out = torch.zeros((n,) + src.shape[1:], dtype=src.dtype)
    return out.index_add_(0, seg, src)
def _pad(x, pw):
    flat = tuple(v for pair in reversed(pw) for v in pair)
    return torch.nn.functional.pad(x, flat)

kernel_name = 'gated_mix__linear_kernel_hedgehog__sliding_block__prompt'

def setup_inputs():

    _w = (lambda a: (lambda t: t.to(torch.bfloat16) if t.is_floating_point() else t)(torch.as_tensor(a)))
    def _A_setup():
        B, S, D, H = 1, 2048, 576, 32
        Dh = D // H
        return {
            "x": _w((lambda *s: torch.randn(*s, dtype=torch.bfloat16) * 0.05)(B, S, D)),
            "wqkv": _w((lambda *s: torch.randn(*s, dtype=torch.bfloat16) * 1.6)(D, 3 * D)),
            "w_phi": _w((lambda *s: torch.randn(*s, dtype=torch.bfloat16) * 1.6)(H, Dh, Dh) * (Dh ** -0.5)),
            "wo": _w((lambda *s: torch.randn(*s, dtype=torch.bfloat16) * 0.1)(D, D)),
        }
    _A_in = _A_setup()

    def _B_setup():
        B, S, D = 1, 2048, 576
        return {
            "x": _w((lambda *s: torch.randn(*s, dtype=torch.bfloat16) * 0.05)(B, S, D)),
            "wqkv": _w((lambda *s: torch.randn(*s, dtype=torch.bfloat16) * 0.8)(D, 3 * D)),
            "wo": _w((lambda *s: torch.randn(*s, dtype=torch.bfloat16) * 0.05)(D, D)),
        }
    _B_in = _B_setup()

    return {
        "A_x": _A_in["x"],
        "A_wqkv": _A_in["wqkv"],
        "A_w_phi": _A_in["w_phi"],
        "A_wo": _A_in["wo"],
        "B_x": _B_in["x"],
        "B_wqkv": _B_in["wqkv"],
        "B_wo": _B_in["wo"],
        "gate_w": _w((lambda *s: torch.randn(*s, dtype=torch.bfloat16) * 0.05)(576) * 16.0),
    }

def reference(A_x, A_wqkv, A_w_phi, A_wo, B_x, B_wqkv, B_wo, gate_w):
    def _A_ref(x, wqkv, w_phi, wo):
        B, S, D = x.shape
        H = 32; Dh = D // H
        qkv = (lambda x, *d: x.permute(*d))((x @ wqkv).reshape(B, S, 3, H, Dh), 2, 0, 3, 1, 4)
        q, k, v = qkv[0], qkv[1], qkv[2]
        pq = torch.einsum("bhsd,hdf->bhsf", q, w_phi)
        pk = torch.einsum("bhsd,hdf->bhsf", k, w_phi)
        phi_q = torch.concatenate([_softmax(pq, axis=-1), _softmax(-pq, axis=-1)], axis=-1)
        phi_k = torch.concatenate([_softmax(pk, axis=-1), _softmax(-pk, axis=-1)], axis=-1)
        kv = torch.einsum("bhsf,bhsd->bhfd", phi_k, v)
        z  = torch.einsum("bhsf->bhf", phi_k)
        num = torch.einsum("bhqf,bhfd->bhqd", phi_q, kv)
        den = torch.einsum("bhqf,bhf->bhq", phi_q, z)[..., None] + 1e-6
        o = num / den
        return (lambda x, *d: x.permute(*d))(o, 0, 2, 1, 3).reshape(B, S, D) @ wo

    def _B_ref(x, wqkv, wo):
        B, S, D = x.shape
        H = 32; Dh = D // H; W = 256
        qkv = (lambda x, *d: x.permute(*d))((x @ wqkv).reshape(B, S, 3, H, Dh), 2, 0, 3, 1, 4)
        q, k, v = qkv[0], qkv[1], qkv[2]
        scores = torch.einsum("bhqd,bhkd->bhqk", q, k) * (Dh ** -0.5)
        idx = torch.arange(S)
        mask = (idx[:, None] - idx[None, :] >= 0) & (idx[:, None] - idx[None, :] < W)
        scores = torch.where(mask[None, None], scores, -1e9)
        p = _softmax(scores, axis=-1)
        o = torch.einsum("bhqk,bhkd->bhqd", p, v)
        return (lambda x, *d: x.permute(*d))(o, 0, 2, 1, 3).reshape(B, S, D) @ wo

    x = A_x
    g = _sigmoid((x * gate_w).sum(-1, keepdims=True))
    a = _A_ref(x, A_wqkv, A_w_phi, A_wo)
    b = _B_ref(x, B_wqkv, B_wo)
    return g * a + (1 - g) * b
```

```asm
; @launch grid=(256,1,1) block=(256,1,1) lds=163840
.amdgcn_target "amdgcn-amd-amdhsa--gfx950"
.text
.globl gated_mix__linear_kernel_hedgehog__sliding_block__prompt_kernel
.p2align 8
.type gated_mix__linear_kernel_hedgehog__sliding_block__prompt_kernel,@function
gated_mix__linear_kernel_hedgehog__sliding_block__prompt_kernel:
    s_cmp_ge_u32 s2, 256
    s_cbranch_scc1 END
    s_load_dwordx8 s[4:11], s[0:1], 0
    s_load_dwordx8 s[12:19], s[0:1], 40
    s_load_dwordx2 s[20:21], s[0:1], 80
    s_mov_b32 s3, s2
    v_lshrrev_b32 v12, 6, v0
    v_and_b32 v1, 63, v0
    v_readfirstlane_b32 s52, v12
    v_lshlrev_b32 v2, 4, v1
    s_mul_i32 s26, s2, 5462
    s_lshr_b32 s26, s26, 16
    s_mul_i32 s58, s26, 12
    s_sub_u32 s58, s2, s58
    s_lshr_b32 s27, s58, 1
    s_and_b32 s22, s58, 1
    s_and_b32 s58, s27, 1
    s_add_u32 s58, s58, 1
    s_mul_i32 s58, s58, 1152
    s_cmp_lt_u32 s27, 4
    s_cselect_b32 s58, s58, 0
    s_mul_i32 s59, s22, 576
    s_add_u32 s58, s58, s59
    s_lshl_b32 s59, s26, 2
    s_add_u32 s59, s59, s52
    s_mul_i32 s59, s59, 27648
    s_add_u32 s24, s58, s59
    s_mul_i32 s25, s52, 4640
    s_add_u32 s25, s25, 126976
    s_mov_b32 s38, 1990656
    s_mov_b32 s39, 0x00020000
    s_mov_b32 m0, s25
    s_movk_i32 s63, 2880
    v_mul_u32_u24 v13, 1821, v1
    v_lshrrev_b32 v13, 16, v13
    v_mad_u32_u24 v16, v13, s63, v2
    v_add_u32 v12, 64, v1
    v_mul_u32_u24 v13, 1821, v12
    v_lshrrev_b32 v13, 16, v13
    v_mad_u32_u24 v17, v13, s63, v2
    v_add_u32 v12, 128, v1
    v_mul_u32_u24 v13, 1821, v12
    v_lshrrev_b32 v13, 16, v13
    v_mad_u32_u24 v18, v13, s63, v2
    v_add_u32 v12, 192, v1
    v_mul_u32_u24 v13, 1821, v12
    v_lshrrev_b32 v13, 16, v13
    v_mad_u32_u24 v19, v13, s63, v2
    v_add_u32 v12, 256, v1
    v_mul_u32_u24 v13, 1821, v12
    v_lshrrev_b32 v13, 16, v13
    v_mad_u32_u24 v20, v13, s63, v2
    v_bfe_u32 v12, v1, 4, 1
    v_bfe_u32 v13, v1, 3, 1
    v_lshl_add_u32 v13, v13, 1, v12
    s_mov_b32 s60, 129024
    v_mul_lo_u32 v15, v13, s60
    v_and_b32 v13, 0x70, v2
    v_add_u32 v15, v15, v13
    s_lshl_b32 s62, s27, 7
    v_lshrrev_b32 v13, 5, v1
    v_mul_u32_u24 v13, 768, v13
    v_add_u32 v15, v15, v13
    s_lshl_b32 s58, s22, 2
    s_add_u32 s58, s58, s52
    s_mul_i32 s61, s58, 516096
    s_mul_i32 s60, s26, 7168
    s_add_u32 s61, s61, s60
    s_add_u32 s61, s61, 65536
    s_add_u32 s62, s62, s61
    s_add_u32 s62, s62, 6144
    s_lshl_b32 s60, s27, 10
    s_add_u32 s60, s60, s61
    v_mov_b32 v64, -1
    v_mov_b32 v65, -1
    v_mov_b32 v66, -1
    v_mov_b32 v67, -1
    s_lshr_b32 s51, s26, 1
    s_mul_i32 s51, s51, 6
    s_add_u32 s51, s51, s27
    s_lshl_b32 s51, s51, 3
    s_lshl_b32 s58, s58, 1
    s_and_b32 s59, s26, 1
    s_add_u32 s58, s58, s59
    s_lshl_b32 s58, s58, 9
    s_add_u32 s51, s51, s58
    s_add_u32 s51, s51, 4096
    s_mov_b32 s34, 134217728
    s_mov_b32 s35, 0x00020000
    s_lshr_b32 s58, 0x2c, s27
    s_bitcmp1_b32 s58, 0
    s_waitcnt lgkmcnt(0)
    s_cselect_b32 s36, s6, s12
    s_cselect_b32 s37, s7, s13
    s_mov_b32 s32, s20
    s_mov_b32 s33, s21
    s_load_dwordx2 s[56:57], s[20:21], 0
    s_cmp_ge_u32 s3, 216
    s_cbranch_scc1 P0B
P0A:
    buffer_store_dwordx4 v[64:67], v2, s[32:35], s60 offen sc1
    s_add_u32 s58, s60, 129024
    buffer_store_dwordx4 v[64:67], v2, s[32:35], s58 offen sc1
    s_add_u32 s58, s60, 258048
    buffer_store_dwordx4 v[64:67], v2, s[32:35], s58 offen sc1
    s_add_u32 s58, s60, 387072
    buffer_store_dwordx4 v[64:67], v2, s[32:35], s58 offen sc1
    s_cmp_eq_u32 s27, 0
    s_cselect_b32 exec_hi, -1, 0
    buffer_store_dwordx4 v[64:67], v15, s[32:35], s62 offen sc1
    s_mov_b64 exec, -1
    buffer_load_dwordx4 v16, s[36:39], s24 offen offset:0 lds
    buffer_load_dwordx4 v17, s[36:39], s24 offen offset:1024 lds
    buffer_load_dwordx4 v18, s[36:39], s24 offen offset:2048 lds
    buffer_load_dwordx4 v19, s[36:39], s24 offen offset:3072 lds
    s_mov_b32 exec_hi, 0
    s_add_u32 m0, s25, 4096
    v_add_u32 v20, 4096, v20
    buffer_load_dwordx4 v20, s[36:39], s24 offen offset:0 lds
    s_mov_b64 exec, -1
    s_mov_b32 s40, s16
    s_mov_b32 s41, s17
    s_mov_b32 s42, 1152
    s_mov_b32 s43, 0x00020000
    v_and_b32 v12, 48, v2
    s_lshl_b32 s58, s26, 6
    buffer_load_dwordx4 v[24:27], v12, s[40:43], s58 offen
    s_and_b32 s58, s2, 3
    s_lshl_b32 s58, s58, 1
    s_bfe_u32 s59, s2, 0x10003
    s_add_u32 s54, s58, s59
    s_lshr_b32 s55, s2, 5
    s_and_b32 s58, s2, 4
    s_lshl_b32 s58, s58, 2
    s_lshr_b32 s59, s2, 4
    s_add_u32 s53, s58, s59
    s_lshl_b32 s50, s55, 7
    s_mul_i32 s101, s52, 24576
    v_lshrrev_b32 v12, 3, v1
    v_mul_u32_u24 v12, 1152, v12
    v_lshrrev_b32 v13, 4, v1
    v_and_b32 v14, 7, v1
    v_xor_b32 v14, v13, v14
    v_lshl_add_u32 v4, v14, 4, v12
    v_xor_b32 v14, 4, v14
    v_lshl_add_u32 v5, v14, 4, v12
    v_add_u32 v5, 8192, v5
    v_add_u32 v6, 16384, v4
    v_add_u32 v7, 16384, v5
    s_lshl_b32 s58, s54, 3
    s_add_u32 s59, s58, s52
    s_mul_i32 s48, s59, 36864
    s_sub_u32 s59, s58, s52
    s_add_u32 s59, s59, 7
    s_mul_i32 s49, s59, 36864
    s_mov_b32 s28, s4
    s_mov_b32 s29, s5
    s_mov_b32 s30, 2359296
    s_mov_b32 s31, 0x00020000
    v_and_b32 v12, 15, v1
    v_lshrrev_b32 v13, 4, v1
    v_lshrrev_b32 v14, 1, v12
    v_xor_b32 v14, v13, v14
    v_lshlrev_b32 v12, 7, v12
    v_lshl_add_u32 v12, v14, 4, v12
    v_add_u32 v8, s101, v12
    v_xor_b32 v9, 64, v8
    s_mul_i32 s58, s53, 648
    s_add_u32 s44, s8, s58
    s_addc_u32 s45, s9, 0
    s_mov_b32 s46, 648
    s_mov_b32 s47, 0x00020000
    s_lshl_b32 s58, s52, 8
    v_lshlrev_b32 v12, 2, v0
    s_add_u32 m0, s58, 162816
    s_nop 0
    buffer_load_dword v12, s[44:47], 0 offen lds
    v_lshrrev_b32 v16, 4, v1
    v_bfe_u32 v18, v1, 2, 2
    v_mul_u32_u24 v18, 576, v18
    s_mul_i32 s58, s52, 144
    s_add_u32 s58, s58, 126976
    v_add_u32 v18, s58, v18
    v_and_b32 v17, 3, v1
    v_mul_u32_u24 v12, 4640, v16
    v_lshl_add_u32 v12, v17, 3, v12
    v_add_u32 v12, v12, v18
    v_lshrrev_b32 v13, 1, v17
    v_mul_u32_u24 v13, 72, v13
    v_add_u32 v18, v18, v13
    v_and_b32 v17, 1, v17
    v_and_b32 v16, 1, v16
    v_lshl_add_u32 v17, v17, 1, v16
    s_movk_i32 s58, 4640
    v_mad_u32_u24 v13, v17, s58, v18
    v_xor_b32 v17, 1, v17
    v_mad_u32_u24 v14, v17, s58, v18
    s_waitcnt lgkmcnt(0)
    s_add_u32 s56, s56, 0x9e3779b9
    s_addc_u32 s57, s57, 0x7f4a7c15
    v_accvgpr_write_b32 a254, s56
    v_accvgpr_write_b32 a255, s57
    s_sub_u32 s98, 255, s3
    s_lshr_b32 s4, s98, 2
    s_and_b32 s5, s98, 3
    s_sub_u32 s8, s98, 144
    s_lshl_b32 s6, s52, 6
    s_cmp_lt_u32 s98, 144
    s_cselect_b32 s4, s4, s8
    s_cselect_b32 s5, s5, s52
    s_cselect_b32 s6, s6, 256
    s_cselect_b32 s7, 16, 8
    s_cselect_b32 s8, 0, 268435456
    v_add_u32 v51, s8, v2
    s_cmp_lt_u32 s98, 180
    s_cselect_b32 s8, 0, 268435456
    s_cselect_b32 s38, 663552, 0
    s_mov_b32 s39, 0x00020000
    s_mov_b32 s42, s38
    s_mov_b32 s43, 0x00020000
    v_add_u32 v50, s8, v2
    s_bfe_u32 s8, s4, 0x20002
    s_and_b32 s9, s4, 3
    s_lshr_b32 s13, s4, 4
    s_lshl_b32 s16, s13, 2
    s_add_u32 s16, s16, s9
    s_and_b32 s17, s4, 15
    s_mul_i32 s17, s17, 36
    s_mul_i32 s20, s9, 144
    s_add_u32 s20, s20, 16
    s_cmp_lt_u32 s4, 32
    s_cselect_b32 s8, s8, s9
    s_cselect_b32 s16, s16, 8
    s_cselect_b32 s17, s17, s20
    s_cselect_b32 s21, 23040, 0
    s_cselect_b32 s96, 4, 36
    s_cselect_b32 s97, 8, 2
    s_cselect_b64 vcc, -1, 0
    s_cmp_lt_u32 s4, 16
    s_cselect_b32 s40, s10, s14
    s_cselect_b32 s41, s11, s15
    s_cmp_eq_u32 s13, 1
    s_cselect_b32 s36, s14, s10
    s_cselect_b32 s37, s15, s11
    s_mul_i32 s17, s17, 1152
    s_mul_i32 s20, s5, 288
    s_add_u32 s17, s17, s20
    s_add_u32 s17, s17, s6
    s_add_u32 s21, s21, s17
    s_xor_b32 s12, s8, s52
    s_cmp_lt_u32 s98, 144
    s_cselect_b32 s12, s12, 4
    s_mul_i32 s9, s16, 9
    s_mul_i32 s16, s16, 5
    s_add_u32 s16, s16, s12
    s_lshl_b32 s12, s12, 1
    s_add_u32 s12, s12, s9
    s_lshl_b32 s5, s5, 2
    s_add_u32 s5, s5, s8
    s_mul_i32 s8, s5, 81
    s_add_u32 s8, s8, s12
    s_lshl_b32 s8, s8, 10
    s_add_u32 s0, s8, 4194304
    s_lshl_b32 s5, s5, 6
    s_add_u32 s5, s5, s16
    s_lshl_b32 s5, s5, 3
    s_add_u32 s1, s5, 40960
    s_lshl_b32 s20, s52, 11
    s_add_u32 s20, s20, 147456
    s_lshl_b32 s97, s97, 6
    v_lshrrev_b32 v44, 4, v1
    v_bfe_u32 v45, v1, 2, 2
    v_lshrrev_b32 v46, 1, v44
    v_lshl_add_u32 v46, v46, 4, v45
    v_and_b32 v47, 1, v44
    v_lshl_add_u32 v46, v47, 2, v46
    v_lshrrev_b32 v47, 1, v45
    v_lshl_add_u32 v47, v47, 2, v44
    v_and_b32 v48, 1, v45
    v_lshl_add_u32 v47, v47, 2, v48
    v_cndmask_b32 v46, v47, v46, vcc
    v_lshl_add_u32 v46, v46, 6, s20
    v_and_b32 v47, 3, v1
    v_mad_u32_u24 v48, v47, s7, v46
    v_add_u32 v49, s97, v48
    v_mad_u32_u24 v45, v44, s96, v45
    v_mul_u32_u24 v45, 1152, v45
    v_lshl_add_u32 v44, v47, 4, v45
    s_waitcnt vmcnt(7)
    s_mov_b64 exec, 1
    buffer_store_dwordx2 a[254:255], off, s[32:35], s51 sc1
    s_mov_b64 exec, -1
    s_waitcnt vmcnt(7)
    s_add_u32 s58, s50, s48
    s_add_u32 m0, s101, 0
    s_nop 0
    buffer_load_dwordx4 v4, s[28:31], s58 offen offset:0 lds
    buffer_load_dwordx4 v5, s[28:31], s58 offen offset:1024 lds
    buffer_load_dwordx4 v6, s[28:31], s58 offen offset:2048 lds
    buffer_load_dwordx4 v7, s[28:31], s58 offen offset:3072 lds
    s_waitcnt vmcnt(6)
    s_barrier
    ds_read_b64_tr_b16 v[72:73], v12 offset:0
    ds_read_b64_tr_b16 v[74:75], v12 offset:2304
    ds_read_b64_tr_b16 v[76:77], v12 offset:40
    ds_read_b64_tr_b16 v[78:79], v12 offset:2344
    ds_read_b64_tr_b16 v[80:81], v12 offset:72
    ds_read_b64_tr_b16 v[82:83], v12 offset:2376
    ds_read_b64_tr_b16 v[84:85], v12 offset:112
    ds_read_b64_tr_b16 v[86:87], v12 offset:2416
    ds_read_b64_tr_b16 v[88:89], v13 offset:32
    ds_read_b64_tr_b16 v[90:91], v13 offset:2336
    ds_read_b64_tr_b16 v[92:93], v14 offset:32
    ds_read_b64_tr_b16 v[94:95], v14 offset:2336
    s_mov_b32 vcc_lo, 0xcccc3333
    s_waitcnt lgkmcnt(10)
    buffer_store_dwordx4 v[72:75], v2, s[32:35], s60 offen sc1
    s_add_u32 s60, s60, 129024
    s_waitcnt lgkmcnt(8)
    buffer_store_dwordx4 v[76:79], v2, s[32:35], s60 offen sc1
    s_add_u32 s60, s60, 129024
    s_waitcnt lgkmcnt(6)
    buffer_store_dwordx4 v[80:83], v2, s[32:35], s60 offen sc1
    s_add_u32 s60, s60, 129024
    s_waitcnt lgkmcnt(4)
    buffer_store_dwordx4 v[84:87], v2, s[32:35], s60 offen sc1
    s_mov_b32 exec_hi, 0
    s_waitcnt lgkmcnt(1)
    v_cndmask_b32_dpp v24, v92, v88, vcc quad_perm:[2,3,0,1] row_mask:0xf bank_mask:0xf
    v_cndmask_b32_dpp v25, v93, v89, vcc quad_perm:[2,3,0,1] row_mask:0xf bank_mask:0xf
    s_waitcnt lgkmcnt(0)
    v_cndmask_b32_dpp v26, v94, v90, vcc quad_perm:[2,3,0,1] row_mask:0xf bank_mask:0xf
    v_cndmask_b32_dpp v27, v95, v91, vcc quad_perm:[2,3,0,1] row_mask:0xf bank_mask:0xf
    s_cmp_eq_u32 s27, 0
    s_cselect_b32 exec_hi, -1, 0
    buffer_store_dwordx4 v[24:27], v15, s[32:35], s62 offen sc1
    s_mov_b64 exec, -1
    s_mov_b32 m0, s20
    s_nop 0
    buffer_load_dwordx4 v44, s[36:39], s17 offen lds
    s_add_u32 m0, s20, 1024
    s_nop 0
    buffer_load_dwordx4 v44, s[40:43], s21 offen lds
    s_add_u32 s58, s50, s49
    s_add_u32 m0, s101, 4096
    s_nop 0
    buffer_load_dwordx4 v4, s[28:31], s58 offen offset:0 lds
    buffer_load_dwordx4 v5, s[28:31], s58 offen offset:1024 lds
    buffer_load_dwordx4 v6, s[28:31], s58 offen offset:2048 lds
    buffer_load_dwordx4 v7, s[28:31], s58 offen offset:3072 lds
    s_add_u32 s50, s50, 128
    s_cmp_eq_u32 s50, 1152
    s_cselect_b32 s50, 0, s50
    s_add_u32 s58, s50, s48
    s_add_u32 m0, s101, 8192
    s_nop 0
    buffer_load_dwordx4 v4, s[28:31], s58 offen offset:0 lds
    buffer_load_dwordx4 v5, s[28:31], s58 offen offset:1024 lds
    buffer_load_dwordx4 v6, s[28:31], s58 offen offset:2048 lds
    buffer_load_dwordx4 v7, s[28:31], s58 offen offset:3072 lds
    s_add_u32 s58, s50, s49
    s_add_u32 m0, s101, 12288
    s_nop 0
    buffer_load_dwordx4 v4, s[28:31], s58 offen offset:0 lds
    buffer_load_dwordx4 v5, s[28:31], s58 offen offset:1024 lds
    buffer_load_dwordx4 v6, s[28:31], s58 offen offset:2048 lds
    buffer_load_dwordx4 v7, s[28:31], s58 offen offset:3072 lds
    s_add_u32 s50, s50, 128
    s_cmp_eq_u32 s50, 1152
    s_cselect_b32 s50, 0, s50
    s_waitcnt lgkmcnt(0)
P0J:
    s_mul_i32 s62, s52, 3584
    s_mul_i32 s51, s53, 129024
    s_add_u32 s51, s51, s62
    s_add_u32 s51, s51, 65536
    s_mul_i32 s63, s55, 14336
    s_lshr_b32 s59, s53, 2
    s_lshl_b32 s59, s59, 1
    s_lshr_b32 s60, s52, 1
    s_add_u32 s59, s59, s60
    s_lshl_b32 s59, s59, 9
    s_add_u32 s59, s59, 4096
    v_min_u32 v12, 53, v1
    v_lshlrev_b32 v12, 3, v12
    s_mov_b32 s100, 0
    buffer_load_dwordx2 v[32:33], v12, s[32:35], s59 offen sc1
    s_waitcnt vmcnt(0)
    v_cmp_ne_u64 vcc, s[56:57], v[32:33]
    s_and_b64 s[96:97], vcc, -1
    s_cbranch_scc1 ol_4
wd_3:
    s_add_u32 s58, s63, s51
    s_add_u32 m0, s62, 98304
    s_nop 0
    buffer_load_dwordx4 v2, s[32:35], s58 offen offset:0 sc1 lds
    buffer_load_dwordx4 v2, s[32:35], s58 offen offset:1024 sc1 lds
    buffer_load_dwordx4 v2, s[32:35], s58 offen offset:2048 sc1 lds
    s_mov_b32 exec_hi, 0
    buffer_load_dwordx4 v2, s[32:35], s58 offen offset:3072 sc1 lds
    s_mov_b32 exec_hi, -1
    s_add_u32 s63, s63, 14336
    s_cmp_eq_u32 s63, 129024
    s_cselect_b32 s63, 0, s63
    s_add_u32 s58, s63, s51
    s_add_u32 m0, s62, 112640
    s_nop 0
    buffer_load_dwordx4 v2, s[32:35], s58 offen offset:0 sc1 lds
    buffer_load_dwordx4 v2, s[32:35], s58 offen offset:1024 sc1 lds
    buffer_load_dwordx4 v2, s[32:35], s58 offen offset:2048 sc1 lds
    s_mov_b32 exec_hi, 0
    buffer_load_dwordx4 v2, s[32:35], s58 offen offset:3072 sc1 lds
    s_mov_b32 exec_hi, -1
    s_add_u32 s63, s63, 14336
    s_cmp_eq_u32 s63, 129024
    s_cselect_b32 s63, 0, s63
    ds_read_b64_tr_b16 v[52:53], v48 offset:0
    ds_read_b64_tr_b16 v[54:55], v49 offset:0
    ds_read_b64_tr_b16 v[56:57], v48 offset:8
    ds_read_b64_tr_b16 v[58:59], v49 offset:8
    s_waitcnt lgkmcnt(2)
    buffer_store_dwordx4 v[52:55], v50, s[32:35], s0 offen sc1
    s_waitcnt lgkmcnt(0)
    buffer_store_dwordx4 v[56:59], v51, s[32:35], s0 offen offset:1024 sc1
    s_add_u32 s58, s50, s48
    s_add_u32 m0, s101, 16384
    s_nop 0
    buffer_load_dwordx4 v4, s[28:31], s58 offen offset:0 lds
    buffer_load_dwordx4 v5, s[28:31], s58 offen offset:1024 lds
    buffer_load_dwordx4 v6, s[28:31], s58 offen offset:2048 lds
    buffer_load_dwordx4 v7, s[28:31], s58 offen offset:3072 lds
    s_add_u32 s58, s50, s49
    s_add_u32 m0, s101, 20480
    s_nop 0
    buffer_load_dwordx4 v4, s[28:31], s58 offen offset:0 lds
    buffer_load_dwordx4 v5, s[28:31], s58 offen offset:1024 lds
    buffer_load_dwordx4 v6, s[28:31], s58 offen offset:2048 lds
    buffer_load_dwordx4 v7, s[28:31], s58 offen offset:3072 lds
    s_add_u32 s50, s50, 128
    s_cmp_eq_u32 s50, 1152
    s_cselect_b32 s50, 0, s50
    ds_read_b128 a[0:3], v8 offset:0
    ds_read_b128 a[4:7], v8 offset:2048
    ds_read_b128 a[8:11], v8 offset:4096
    ds_read_b128 a[12:15], v8 offset:6144
    ds_read_b128 a[16:19], v9 offset:0
    ds_read_b128 a[20:23], v9 offset:2048
    ds_read_b128 a[24:27], v9 offset:4096
    ds_read_b128 a[28:31], v9 offset:6144
    v_and_b32 v12, 15, v1
    v_lshrrev_b32 v13, 4, v1
    v_lshrrev_b32 v11, 1, v12
    v_lshlrev_b32 v11, 7, v11
    v_lshl_add_u32 v11, v13, 5, v11
    v_and_b32 v14, 16, v2
    v_add_u32 v11, v11, v14
    v_lshlrev_b32 v13, 4, v13
    v_add_u32 v13, 0x300, v13
    v_cmp_gt_u32 vcc, 12, v12
    s_nop 1
    v_cndmask_b32 v11, v13, v11, vcc
    v_add_u32 v11, 104448, v11
    v_add_u32 v10, 98304, v2
    s_waitcnt vmcnt(14) lgkmcnt(0)
    s_barrier
    ds_read_b128 v[72:75], v10 offset:0
    ds_read_b128 v[76:79], v10 offset:1024
    ds_read_b128 v[80:83], v10 offset:2048
    ds_read_b128 v[84:87], v10 offset:3072
    ds_read_b128 v[88:91], v10 offset:4096
    ds_read_b128 v[92:95], v10 offset:5120
    ds_read_b128 v[96:99], v11 offset:0
    s_waitcnt lgkmcnt(4)
    v_max3_u32 v33, v72, v76, v80
    s_waitcnt lgkmcnt(2)
    v_max3_u32 v33, v84, v88, v33
    s_waitcnt lgkmcnt(0)
    v_max3_u32 v33, v92, v96, v33
    v_cmp_eq_u32 s[96:97], -1, v33
    s_cmp_lg_u64 s[96:97], 0
    s_cbranch_scc1 REC0
BK0:
    v_mfma_f32_16x16x32_bf16 v[128:131], v[72:75], a[0:3], 0
    v_mfma_f32_16x16x32_bf16 v[156:159], v[72:75], a[4:7], 0
    ds_read_b128 v[100:103], v10 offset:7168
    s_add_u32 s58, s63, s51
    v_mfma_f32_16x16x32_bf16 v[184:187], v[72:75], a[8:11], 0
    s_add_u32 m0, s62, 126976
    s_mov_b32 s44, s18
    v_mfma_f32_16x16x32_bf16 v[212:215], v[72:75], a[12:15], 0
    buffer_load_dwordx4 v2, s[32:35], s58 offen offset:0 sc1 lds
    ds_read_b128 v[104:107], v10 offset:8192
    v_mfma_f32_16x16x32_bf16 v[132:135], v[76:79], a[0:3], 0
    s_mov_b32 s45, s19
    s_mov_b32 s46, 2359296
    v_mfma_f32_16x16x32_bf16 v[160:163], v[76:79], a[4:7], 0
    ds_read_b128 v[108:111], v10 offset:9216
    v_lshrrev_b32 v64, 5, v1
    v_mfma_f32_16x16x32_bf16 v[188:191], v[76:79], a[8:11], 0
    v_and_b32 v65, 31, v1
    v_bfe_u32 v66, v1, 2, 2
    v_mfma_f32_16x16x32_bf16 v[216:219], v[76:79], a[12:15], 0
    buffer_load_dwordx4 v2, s[32:35], s58 offen offset:1024 sc1 lds
    ds_read_b128 v[112:115], v10 offset:10240
    v_mfma_f32_16x16x32_bf16 v[136:139], v[80:83], a[0:3], 0
    v_and_b32 v67, 3, v1
    v_bfe_u32 v68, v1, 4, 1
    v_mfma_f32_16x16x32_bf16 v[164:167], v[80:83], a[4:7], 0
    ds_read_b128 v[116:119], v10 offset:11264
    s_and_b32 s16, s53, 1
    v_mfma_f32_16x16x32_bf16 v[192:195], v[80:83], a[8:11], 0
    s_mul_i32 s17, s16, 72
    s_add_u32 s17, s17, 162816
    v_mfma_f32_16x16x32_bf16 v[220:223], v[80:83], a[12:15], 0
    buffer_load_dwordx4 v2, s[32:35], s58 offen offset:2048 sc1 lds
    ds_read_b128 v[120:123], v10 offset:12288
    v_mfma_f32_16x16x32_bf16 v[140:143], v[84:87], a[0:3], 0
    s_mul_i32 s16, s16, 576
    s_sub_u32 s16, 163392, s16
    v_mfma_f32_16x16x32_bf16 v[168:171], v[84:87], a[4:7], 0
    ds_read_b128 v[124:127], v11 offset:7168
    v_lshrrev_b32 v69, 3, v65
    v_mfma_f32_16x16x32_bf16 v[196:199], v[84:87], a[8:11], 0
    v_lshl_add_u32 v69, v69, 2, v67
    v_lshlrev_b32 v69, 1, v69
    v_mfma_f32_16x16x32_bf16 v[224:227], v[84:87], a[12:15], 0
    s_mov_b32 exec_hi, 0
    buffer_load_dwordx4 v2, s[32:35], s58 offen offset:3072 sc1 lds
    s_mov_b32 exec_hi, -1
    v_mfma_f32_16x16x32_bf16 v[144:147], v[88:91], a[0:3], 0
    ds_read_b128 a[32:35], v8 offset:8192
    s_add_u32 s63, s63, 14336
    v_mfma_f32_16x16x32_bf16 v[172:175], v[88:91], a[4:7], 0
    s_cmp_eq_u32 s63, 129024
    s_cselect_b32 s63, 0, s63
    v_mfma_f32_16x16x32_bf16 v[200:203], v[88:91], a[8:11], 0
    ds_read_b128 a[36:39], v8 offset:10240
    s_waitcnt lgkmcnt(6)
    v_max3_u32 v33, v100, v104, v108
    v_mfma_f32_16x16x32_bf16 v[228:231], v[88:91], a[12:15], 0
    s_waitcnt lgkmcnt(4)
    v_max3_u32 v33, v112, v116, v33
    s_add_u32 s58, s50, s48
    v_mfma_f32_16x16x32_bf16 v[148:151], v[92:95], a[0:3], 0
    ds_read_b128 a[40:43], v8 offset:12288
    s_waitcnt lgkmcnt(3)
    v_max3_u32 v33, v120, v124, v33
    v_mfma_f32_16x16x32_bf16 v[176:179], v[92:95], a[4:7], 0
    v_cmp_eq_u32 s[96:97], -1, v33
    s_add_u32 m0, s101, 0
    v_mfma_f32_16x16x32_bf16 v[204:207], v[92:95], a[8:11], 0
    buffer_load_dwordx4 v4, s[28:31], s58 offen offset:0 lds
    v_mfma_f32_16x16x32_bf16 v[232:235], v[92:95], a[12:15], 0
    ds_read_b128 a[44:47], v8 offset:14336
    v_and_b32 v70, 1, v1
    v_mfma_f32_16x16x32_bf16 v[152:155], v[96:99], a[0:3], 0
    s_cmp_lg_u64 s[96:97], 0
    s_cbranch_scc1 REC1
BK1:
    v_mfma_f32_16x16x32_bf16 v[180:183], v[96:99], a[4:7], 0
    ds_read_b128 a[48:51], v9 offset:8192
    v_lshl_add_u32 v70, v70, 1, 32
    v_mfma_f32_16x16x32_bf16 v[208:211], v[96:99], a[8:11], 0
    buffer_load_dwordx4 v5, s[28:31], s58 offen offset:1024 lds
    v_mul_u32_u24 v71, 288, v64
    v_mfma_f32_16x16x32_bf16 v[236:239], v[96:99], a[12:15], 0
    ds_read_b128 a[52:55], v9 offset:10240
    v_add3_u32 v60, v69, v71, s17
    v_mfma_f32_16x16x32_bf16 v[128:131], v[100:103], a[16:19], v[128:131]
    v_add3_u32 v61, v70, v71, s17
    v_add_u32 v62, s16, v69
    v_mfma_f32_16x16x32_bf16 v[156:159], v[100:103], a[20:23], v[156:159]
    s_waitcnt vmcnt(16)
    s_barrier
    v_mfma_f32_16x16x32_bf16 v[184:187], v[100:103], a[24:27], v[184:187]
    buffer_load_dwordx4 v6, s[28:31], s58 offen offset:2048 lds
    ds_read_b128 v[72:75], v10 offset:14336
    v_mfma_f32_16x16x32_bf16 v[212:215], v[100:103], a[28:31], v[212:215]
    v_add_u32 v63, s16, v70
    ds_read_u16 v40, v60 offset:0
    v_mfma_f32_16x16x32_bf16 v[132:135], v[104:107], a[16:19], v[132:135]
    ds_read_b128 v[76:79], v10 offset:15360
    ds_read_u16 v41, v60 offset:36
    v_mfma_f32_16x16x32_bf16 v[160:163], v[104:107], a[20:23], v[160:163]
    ds_read_u16 v42, v60 offset:72
    ds_read_u16 v43, v60 offset:108
    v_mfma_f32_16x16x32_bf16 v[188:191], v[104:107], a[24:27], v[188:191]
    buffer_load_dwordx4 v7, s[28:31], s58 offen offset:3072 lds
    ds_read_b128 v[80:83], v10 offset:16384
    v_mfma_f32_16x16x32_bf16 v[216:219], v[104:107], a[28:31], v[216:219]
    s_add_u32 s58, s63, s51
    s_add_u32 m0, s62, 141312
    v_mfma_f32_16x16x32_bf16 v[136:139], v[108:111], a[16:19], v[136:139]
    ds_read_b128 v[84:87], v10 offset:17408
    ds_read_u16 v44, v60 offset:144
    v_mfma_f32_16x16x32_bf16 v[164:167], v[108:111], a[20:23], v[164:167]
    ds_read_u16 v45, v60 offset:180
    ds_read_u16 v46, v60 offset:216
    v_mfma_f32_16x16x32_bf16 v[192:195], v[108:111], a[24:27], v[192:195]
    buffer_load_dwordx4 v2, s[32:35], s58 offen offset:0 sc1 lds
    ds_read_b128 v[88:91], v10 offset:18432
    v_mfma_f32_16x16x32_bf16 v[220:223], v[108:111], a[28:31], v[220:223]
    ds_read_u16 v47, v60 offset:252
    ds_read_u16 v48, v61 offset:0
    v_mfma_f32_16x16x32_bf16 v[140:143], v[112:115], a[16:19], v[140:143]
    ds_read_b128 v[92:95], v10 offset:19456
    ds_read_u16 v49, v61 offset:36
    v_mfma_f32_16x16x32_bf16 v[168:171], v[112:115], a[20:23], v[168:171]
    ds_read_u16 v50, v61 offset:72
    ds_read_u16 v51, v61 offset:108
    v_mfma_f32_16x16x32_bf16 v[196:199], v[112:115], a[24:27], v[196:199]
    buffer_load_dwordx4 v2, s[32:35], s58 offen offset:1024 sc1 lds
    ds_read_b128 v[96:99], v11 offset:14336
    v_mfma_f32_16x16x32_bf16 v[224:227], v[112:115], a[28:31], v[224:227]
    ds_read_u16 v52, v61 offset:144
    ds_read_u16 v53, v61 offset:180
    v_mfma_f32_16x16x32_bf16 v[144:147], v[116:119], a[16:19], v[144:147]
    ds_read_b128 a[56:59], v9 offset:12288
    ds_read_u16 v54, v61 offset:216
    v_mfma_f32_16x16x32_bf16 v[172:175], v[116:119], a[20:23], v[172:175]
    ds_read_u16 v55, v61 offset:252
    ds_read_u16 v56, v62 offset:0
    v_mfma_f32_16x16x32_bf16 v[200:203], v[116:119], a[24:27], v[200:203]
    buffer_load_dwordx4 v2, s[32:35], s58 offen offset:2048 sc1 lds
    ds_read_b128 a[60:63], v9 offset:14336
    v_mfma_f32_16x16x32_bf16 v[228:231], v[116:119], a[28:31], v[228:231]
    s_waitcnt lgkmcnt(15)
    v_max3_u32 v33, v72, v76, v80
    ds_read_u16 v57, v62 offset:36
    v_mfma_f32_16x16x32_bf16 v[148:151], v[120:123], a[16:19], v[148:151]
    s_waitcnt lgkmcnt(15)
    v_max3_u32 v33, v84, v88, v33
    ds_read_u16 v58, v63 offset:0
    v_mfma_f32_16x16x32_bf16 v[176:179], v[120:123], a[20:23], v[176:179]
    s_waitcnt lgkmcnt(9)
    v_max3_u32 v33, v92, v96, v33
    ds_read_u16 v59, v63 offset:36
    v_mfma_f32_16x16x32_bf16 v[204:207], v[120:123], a[24:27], v[204:207]
    s_mov_b32 exec_hi, 0
    buffer_load_dwordx4 v2, s[32:35], s58 offen offset:3072 sc1 lds
    s_mov_b32 exec_hi, -1
    v_mfma_f32_16x16x32_bf16 v[232:235], v[120:123], a[28:31], v[232:235]
    v_cmp_eq_u32 s[96:97], -1, v33
    s_add_u32 s63, s63, 14336
    v_mfma_f32_16x16x32_bf16 v[152:155], v[124:127], a[16:19], v[152:155]
    s_cmp_lg_u64 s[96:97], 0
    s_cbranch_scc1 REC2
BK2:
    v_mfma_f32_16x16x32_bf16 v[180:183], v[124:127], a[20:23], v[180:183]
    s_cmp_eq_u32 s63, 129024
    s_cselect_b32 s63, 0, s63
    v_mfma_f32_16x16x32_bf16 v[208:211], v[124:127], a[24:27], v[208:211]
    s_add_u32 s58, s63, s51
    s_add_u32 m0, s62, 98304
    v_mfma_f32_16x16x32_bf16 v[236:239], v[124:127], a[28:31], v[236:239]
    buffer_load_dwordx4 v2, s[32:35], s58 offen offset:0 sc1 lds
    s_mov_b32 s22, 0x3fb8aa3b
    v_mfma_f32_16x16x32_bf16 v[128:131], v[72:75], a[32:35], v[128:131]
    s_mov_b32 s23, s22
    s_mov_b32 s24, 0x3eae1a93
    v_mfma_f32_16x16x32_bf16 v[156:159], v[72:75], a[36:39], v[156:159]
    ds_read_b128 v[100:103], v10 offset:21504
    s_mov_b32 s14, 0
    v_mfma_f32_16x16x32_bf16 v[184:187], v[72:75], a[40:43], v[184:187]
    s_mov_b32 s15, -1
    s_lshl_b32 s16, s53, 3
    v_mfma_f32_16x16x32_bf16 v[212:215], v[72:75], a[44:47], v[212:215]
    buffer_load_dwordx4 v2, s[32:35], s58 offen offset:1024 sc1 lds
    ds_read_b128 v[104:107], v10 offset:22528
    v_mfma_f32_16x16x32_bf16 v[132:135], v[76:79], a[32:35], v[132:135]
    s_add_u32 s16, s16, s54
    s_mul_i32 s25, s16, 20480
    v_mfma_f32_16x16x32_bf16 v[160:163], v[76:79], a[36:39], v[160:163]
    ds_read_b128 v[108:111], v10 offset:23552
    s_add_u32 s25, s25, 6291456
    v_mfma_f32_16x16x32_bf16 v[188:191], v[76:79], a[40:43], v[188:191]
    s_sub_u32 s26, s25, 20480
    s_lshl_b32 s16, s16, 2
    v_mfma_f32_16x16x32_bf16 v[216:219], v[76:79], a[44:47], v[216:219]
    buffer_load_dwordx4 v2, s[32:35], s58 offen offset:2048 sc1 lds
    ds_read_b128 v[112:115], v10 offset:24576
    v_mfma_f32_16x16x32_bf16 v[136:139], v[80:83], a[32:35], v[136:139]
    s_add_u32 s16, s16, s52
    s_lshl_b32 s16, s16, 3
    v_mfma_f32_16x16x32_bf16 v[164:167], v[80:83], a[36:39], v[164:167]
    ds_read_b128 v[116:119], v10 offset:25600
    s_add_u32 s27, s16, 16384
    v_mfma_f32_16x16x32_bf16 v[192:195], v[80:83], a[40:43], v[192:195]
    s_sub_u32 s36, s27, 32
    s_lshl_b32 s16, s53, 2
    v_mfma_f32_16x16x32_bf16 v[220:223], v[80:83], a[44:47], v[220:223]
    s_mov_b32 exec_hi, 0
    buffer_load_dwordx4 v2, s[32:35], s58 offen offset:3072 sc1 lds
    s_mov_b32 exec_hi, -1
    v_mfma_f32_16x16x32_bf16 v[140:143], v[84:87], a[32:35], v[140:143]
    ds_read_b128 v[120:123], v10 offset:26624
    s_add_u32 s63, s63, 14336
    v_mfma_f32_16x16x32_bf16 v[168:171], v[84:87], a[36:39], v[168:171]
    s_cmp_eq_u32 s63, 129024
    s_cselect_b32 s63, 0, s63
    v_mfma_f32_16x16x32_bf16 v[196:199], v[84:87], a[40:43], v[196:199]
    ds_read_b128 v[124:127], v11 offset:21504
    s_add_u32 s58, s50, s49
    v_mfma_f32_16x16x32_bf16 v[224:227], v[84:87], a[44:47], v[224:227]
    s_add_u32 m0, s101, 4096
    s_add_u32 s16, s16, s52
    v_mfma_f32_16x16x32_bf16 v[144:147], v[88:91], a[32:35], v[144:147]
    buffer_load_dwordx4 v4, s[28:31], s58 offen offset:0 lds
    v_mfma_f32_16x16x32_bf16 v[172:175], v[88:91], a[36:39], v[172:175]
    s_waitcnt vmcnt(17)
    ds_read_b128 a[64:67], v8 offset:16384
    s_lshl_b32 s39, s16, 13
    v_mfma_f32_16x16x32_bf16 v[200:203], v[88:91], a[40:43], v[200:203]
    s_add_u32 s39, s39, 12582912
    s_lshl_b32 s17, s54, 10
    v_mfma_f32_16x16x32_bf16 v[228:231], v[88:91], a[44:47], v[228:231]
    ds_read_b128 a[68:71], v8 offset:18432
    s_waitcnt lgkmcnt(6)
    v_max3_u32 v33, v100, v104, v108
    v_mfma_f32_16x16x32_bf16 v[148:151], v[92:95], a[32:35], v[148:151]
    buffer_load_dwordx4 v5, s[28:31], s58 offen offset:1024 lds
    s_waitcnt lgkmcnt(4)
    v_max3_u32 v33, v112, v116, v33
    v_mfma_f32_16x16x32_bf16 v[176:179], v[92:95], a[36:39], v[176:179]
    ds_read_b128 a[72:75], v8 offset:20480
    s_waitcnt lgkmcnt(3)
    v_max3_u32 v33, v120, v124, v33
    v_mfma_f32_16x16x32_bf16 v[204:207], v[92:95], a[40:43], v[204:207]
    v_cmp_eq_u32 s[96:97], -1, v33
    s_add_u32 s37, s39, s17
    v_mfma_f32_16x16x32_bf16 v[232:235], v[92:95], a[44:47], v[232:235]
    ds_read_b128 a[76:79], v8 offset:22528
    s_lshl_b32 s40, s52, 5
    v_mfma_f32_16x16x32_bf16 v[152:155], v[96:99], a[32:35], v[152:155]
    buffer_load_dwordx4 v6, s[28:31], s58 offen offset:2048 lds
    s_add_u32 s40, s40, s53
    v_mfma_f32_16x16x32_bf16 v[180:183], v[96:99], a[36:39], v[180:183]
    ds_read_b128 a[80:83], v9 offset:16384
    s_lshl_b32 s40, s40, 3
    v_mfma_f32_16x16x32_bf16 v[208:211], v[96:99], a[40:43], v[208:211]
    s_cmp_lg_u64 s[96:97], 0
    s_cbranch_scc1 REC3
BK3:
    v_mfma_f32_16x16x32_bf16 v[236:239], v[96:99], a[44:47], v[236:239]
    ds_read_b128 a[84:87], v9 offset:18432
    s_add_u32 s40, s40, 49152
    v_mfma_f32_16x16x32_bf16 v[128:131], v[100:103], a[48:51], v[128:131]
    buffer_load_dwordx4 v7, s[28:31], s58 offen offset:3072 lds
    s_add_u32 s50, s50, 128
    v_mfma_f32_16x16x32_bf16 v[156:159], v[100:103], a[52:55], v[156:159]
    s_waitcnt vmcnt(16)
    s_barrier
    v_mfma_f32_16x16x32_bf16 v[184:187], v[100:103], a[56:59], v[184:187]
    ds_read_b128 v[72:75], v10 offset:28672
    s_mul_i32 s7, s52, 2560
    v_mfma_f32_16x16x32_bf16 v[212:215], v[100:103], a[60:63], v[212:215]
    s_cmp_eq_u32 s50, 1152
    s_cselect_b32 s50, 0, s50
    v_mfma_f32_16x16x32_bf16 v[132:135], v[104:107], a[48:51], v[132:135]
    ds_read_b128 v[76:79], v10 offset:29696
    s_add_u32 s58, s63, s51
    v_mfma_f32_16x16x32_bf16 v[160:163], v[104:107], a[52:55], v[160:163]
    s_add_u32 m0, s62, 112640
    s_sub_u32 s8, 17920, s7
    v_mfma_f32_16x16x32_bf16 v[188:191], v[104:107], a[56:59], v[188:191]
    buffer_load_dwordx4 v2, s[32:35], s58 offen offset:0 sc1 lds
    ds_read_b128 v[80:83], v10 offset:30720
    v_mfma_f32_16x16x32_bf16 v[216:219], v[104:107], a[60:63], v[216:219]
    s_lshl_b32 s4, s52, 13
    s_add_u32 s4, s4, 40960
    v_mfma_f32_16x16x32_bf16 v[136:139], v[108:111], a[48:51], v[136:139]
    ds_read_b128 v[84:87], v10 offset:31744
    s_lshl_b32 s5, s52, 10
    v_mfma_f32_16x16x32_bf16 v[164:167], v[108:111], a[52:55], v[164:167]
    s_add_u32 s5, s5, 40960
    v_bfe_i32 v69, v1, 2, 1
    v_mfma_f32_16x16x32_bf16 v[192:195], v[108:111], a[56:59], v[192:195]
    buffer_load_dwordx4 v2, s[32:35], s58 offen offset:1024 sc1 lds
    ds_read_b128 v[88:91], v10 offset:32768
    v_mfma_f32_16x16x32_bf16 v[220:223], v[108:111], a[60:63], v[220:223]
    v_and_b32 v69, 0x80008000, v69
    v_lshl_or_b32 v240, v41, 16, v40
    v_mfma_f32_16x16x32_bf16 v[140:143], v[112:115], a[48:51], v[140:143]
    ds_read_b128 v[92:95], v10 offset:33792
    v_xor_b32 v240, v69, v240
    v_mfma_f32_16x16x32_bf16 v[168:171], v[112:115], a[52:55], v[168:171]
    v_lshl_or_b32 v241, v43, 16, v42
    v_xor_b32 v241, v69, v241
    v_mfma_f32_16x16x32_bf16 v[196:199], v[112:115], a[56:59], v[196:199]
    buffer_load_dwordx4 v2, s[32:35], s58 offen offset:2048 sc1 lds
    ds_read_b128 v[96:99], v11 offset:28672
    v_mfma_f32_16x16x32_bf16 v[224:227], v[112:115], a[60:63], v[224:227]
    v_lshl_or_b32 v242, v45, 16, v44
    v_xor_b32 v242, v69, v242
    v_mfma_f32_16x16x32_bf16 v[144:147], v[116:119], a[48:51], v[144:147]
    ds_read_b128 a[88:91], v9 offset:20480
    v_lshl_or_b32 v243, v47, 16, v46
    v_mfma_f32_16x16x32_bf16 v[172:175], v[116:119], a[52:55], v[172:175]
    v_xor_b32 v243, v69, v243
    v_lshl_or_b32 v248, v49, 16, v48
    v_mfma_f32_16x16x32_bf16 v[200:203], v[116:119], a[56:59], v[200:203]
    s_mov_b32 exec_hi, 0
    buffer_load_dwordx4 v2, s[32:35], s58 offen offset:3072 sc1 lds
    s_mov_b32 exec_hi, -1
    v_mfma_f32_16x16x32_bf16 v[228:231], v[116:119], a[60:63], v[228:231]
    ds_read_b128 a[92:95], v9 offset:22528
    s_waitcnt lgkmcnt(6)
    v_max3_u32 v33, v72, v76, v80
    v_mfma_f32_16x16x32_bf16 v[148:151], v[120:123], a[48:51], v[148:151]
    s_waitcnt lgkmcnt(4)
    v_max3_u32 v33, v84, v88, v33
    s_add_u32 s63, s63, 14336
    v_mfma_f32_16x16x32_bf16 v[176:179], v[120:123], a[52:55], v[176:179]
    s_waitcnt lgkmcnt(2)
    v_max3_u32 v33, v92, v96, v33
    v_xor_b32 v248, v69, v248
    v_mfma_f32_16x16x32_bf16 v[204:207], v[120:123], a[56:59], v[204:207]
    v_cmp_eq_u32 s[96:97], -1, v33
    v_lshl_or_b32 v249, v51, 16, v50
    v_mfma_f32_16x16x32_bf16 v[232:235], v[120:123], a[60:63], v[232:235]
    s_cmp_lg_u64 s[96:97], 0
    s_cbranch_scc1 REC4
BK4:
    v_mfma_f32_16x16x32_bf16 v[152:155], v[124:127], a[48:51], v[152:155]
    s_cmp_eq_u32 s63, 129024
    s_cselect_b32 s63, 0, s63
    v_mfma_f32_16x16x32_bf16 v[180:183], v[124:127], a[52:55], v[180:183]
    s_add_u32 s58, s50, s48
    s_add_u32 m0, s101, 8192
    v_mfma_f32_16x16x32_bf16 v[208:211], v[124:127], a[56:59], v[208:211]
    buffer_load_dwordx4 v4, s[28:31], s58 offen offset:0 lds
    v_mfma_f32_16x16x32_bf16 v[236:239], v[124:127], a[60:63], v[236:239]
    v_xor_b32 v249, v69, v249
    v_lshl_or_b32 v250, v53, 16, v52
    v_mfma_f32_16x16x32_bf16 v[128:131], v[72:75], a[64:67], v[128:131]
    v_xor_b32 v250, v69, v250
    v_lshl_or_b32 v251, v55, 16, v54
    v_mfma_f32_16x16x32_bf16 v[156:159], v[72:75], a[68:71], v[156:159]
    ds_read_b128 v[100:103], v10 offset:35840
    v_xor_b32 v251, v69, v251
    v_mfma_f32_16x16x32_bf16 v[184:187], v[72:75], a[72:75], v[184:187]
    buffer_load_dwordx4 v5, s[28:31], s58 offen offset:1024 lds
    v_lshl_or_b32 v244, v57, 16, v56
    v_mfma_f32_16x16x32_bf16 v[212:215], v[72:75], a[76:79], v[212:215]
    ds_read_b128 v[104:107], v10 offset:36864
    v_xor_b32 v244, v69, v244
    v_mfma_f32_16x16x32_bf16 v[132:135], v[76:79], a[64:67], v[132:135]
    v_lshl_or_b32 v252, v59, 16, v58
    v_xor_b32 v252, v69, v252
    v_mfma_f32_16x16x32_bf16 v[160:163], v[76:79], a[68:71], v[160:163]
    ds_read_b128 v[108:111], v10 offset:37888
    v_mov_b32 v245, 0
    v_mfma_f32_16x16x32_bf16 v[188:191], v[76:79], a[72:75], v[188:191]
    buffer_load_dwordx4 v6, s[28:31], s58 offen offset:2048 lds
    v_mov_b32 v246, 0
    v_mfma_f32_16x16x32_bf16 v[216:219], v[76:79], a[76:79], v[216:219]
    ds_read_b128 v[112:115], v10 offset:38912
    v_mov_b32 v247, 0
    v_mfma_f32_16x16x32_bf16 v[136:139], v[80:83], a[64:67], v[136:139]
    v_mov_b32 v253, 0
    v_mov_b32 v254, 0
    v_mfma_f32_16x16x32_bf16 v[164:167], v[80:83], a[68:71], v[164:167]
    ds_read_b128 v[116:119], v10 offset:39936
    v_mov_b32 v255, 0
    v_mfma_f32_16x16x32_bf16 v[192:195], v[80:83], a[72:75], v[192:195]
    buffer_load_dwordx4 v7, s[28:31], s58 offen offset:3072 lds
    v_mov_b32 v23, 0
    v_mfma_f32_16x16x32_bf16 v[220:223], v[80:83], a[76:79], v[220:223]
    ds_read_b128 v[120:123], v10 offset:40960
    v_mov_b32 v24, 0
    v_mfma_f32_16x16x32_bf16 v[140:143], v[84:87], a[64:67], v[140:143]
    v_mov_b32 v25, 0
    v_mov_b32 v27, 0
    v_mfma_f32_16x16x32_bf16 v[168:171], v[84:87], a[68:71], v[168:171]
    ds_read_b128 v[124:127], v11 offset:35840
    v_mov_b32 v28, 0
    v_mfma_f32_16x16x32_bf16 v[196:199], v[84:87], a[72:75], v[196:199]
    s_cmp_ge_u32 s3, 76
    s_cselect_b64 exec, 1, 0
    buffer_store_dwordx2 a[254:255], off, s[32:35], s1 sc1
    s_mov_b64 exec, -1
    v_mfma_f32_16x16x32_bf16 v[224:227], v[84:87], a[76:79], v[224:227]
    s_add_u32 s58, s50, s49
    s_add_u32 m0, s101, 12288
    v_mfma_f32_16x16x32_bf16 v[144:147], v[88:91], a[64:67], v[144:147]
    v_mov_b32 v29, 0
    v_mov_b32 v31, 0
    v_mfma_f32_16x16x32_bf16 v[172:175], v[88:91], a[68:71], v[172:175]
    v_mov_b32 v32, 0
    v_mov_b32 v34, -1
    v_mfma_f32_16x16x32_bf16 v[200:203], v[88:91], a[72:75], v[200:203]
    buffer_load_dwordx4 v4, s[28:31], s58 offen offset:0 lds
    v_mfma_f32_16x16x32_bf16 v[228:231], v[88:91], a[76:79], v[228:231]
    s_waitcnt lgkmcnt(4)
    v_max3_u32 v33, v100, v104, v108
    v_mov_b32 v35, -1
    v_mfma_f32_16x16x32_bf16 v[148:151], v[92:95], a[64:67], v[148:151]
    s_waitcnt lgkmcnt(2)
    v_max3_u32 v33, v112, v116, v33
    v_mov_b32 v36, -1
    v_mfma_f32_16x16x32_bf16 v[176:179], v[92:95], a[68:71], v[176:179]
    s_waitcnt lgkmcnt(0)
    v_max3_u32 v33, v120, v124, v33
    v_mov_b32 v37, -1
    v_mfma_f32_16x16x32_bf16 v[204:207], v[92:95], a[72:75], v[204:207]
    buffer_load_dwordx4 v5, s[28:31], s58 offen offset:1024 lds
    v_cmp_eq_u32 s[96:97], -1, v33
    v_mfma_f32_16x16x32_bf16 v[232:235], v[92:95], a[76:79], v[232:235]
    s_cmp_lg_u64 s[96:97], 0
    s_cbranch_scc1 REC5
BK5:
    v_mfma_f32_16x16x32_bf16 v[152:155], v[96:99], a[64:67], v[152:155]
    v_mul_u32_u24 v69, 80, v65
    v_lshl_add_u32 v70, v64, 4, v69
    v_mfma_f32_16x16x32_bf16 v[180:183], v[96:99], a[68:71], v[180:183]
    v_add_u32 v12, s7, v70
    v_add_u32 v13, s8, v70
    v_mfma_f32_16x16x32_bf16 v[208:211], v[96:99], a[72:75], v[208:211]
    buffer_load_dwordx4 v6, s[28:31], s58 offen offset:2048 lds
    v_add_u32 v69, s4, v69
    v_mfma_f32_16x16x32_bf16 v[236:239], v[96:99], a[76:79], v[236:239]
    v_lshl_add_u32 v17, v64, 5, v69
    v_lshl_add_u32 v18, v64, 3, v69
    v_mfma_f32_16x16x32_bf16 v[128:131], v[100:103], a[80:83], v[128:131]
    v_mul_u32_u24 v69, 48, v65
    v_lshl_add_u32 v69, v64, 4, v69
    v_mfma_f32_16x16x32_bf16 v[156:159], v[100:103], a[84:87], v[156:159]
    s_waitcnt vmcnt(20)
    s_barrier
    v_mfma_f32_16x16x32_bf16 v[184:187], v[100:103], a[88:91], v[184:187]
    buffer_load_dwordx4 v7, s[28:31], s58 offen offset:3072 lds
    ds_read_b128 v[72:75], v10 offset:43008
    v_mfma_f32_16x16x32_bf16 v[212:215], v[100:103], a[92:95], v[212:215]
    s_add_u32 s50, s50, 128
    v_add_u32 v16, s4, v69
    v_mfma_f32_16x16x32_bf16 v[132:135], v[104:107], a[80:83], v[132:135]
    ds_read_b128 v[76:79], v10 offset:44032
    v_min_u32 v69, 1, v67
    v_mfma_f32_16x16x32_bf16 v[160:163], v[104:107], a[84:87], v[160:163]
    s_cmp_eq_u32 s50, 1152
    s_cselect_b32 s50, 0, s50
    v_mfma_f32_16x16x32_bf16 v[188:191], v[104:107], a[88:91], v[188:191]
    ds_read_b128 v[80:83], v10 offset:45056
    s_add_u32 s58, s63, s51
    v_mfma_f32_16x16x32_bf16 v[216:219], v[104:107], a[92:95], v[216:219]
    s_add_u32 m0, s62, 126976
    v_add_u32 v69, 4, v69
    v_mfma_f32_16x16x32_bf16 v[136:139], v[108:111], a[80:83], v[136:139]
    buffer_load_dwordx4 v2, s[32:35], s58 offen offset:0 sc1 lds
    ds_read_b128 v[84:87], v10 offset:46080
    v_mfma_f32_16x16x32_bf16 v[164:167], v[108:111], a[84:87], v[164:167]
    v_cmp_eq_u32 vcc, 1, v68
    v_lshl_add_u32 v70, v64, 2, v66
    v_mfma_f32_16x16x32_bf16 v[192:195], v[108:111], a[88:91], v[192:195]
    ds_read_b128 v[88:91], v10 offset:47104
    v_mul_u32_u24 v70, 80, v70
    v_mfma_f32_16x16x32_bf16 v[220:223], v[108:111], a[92:95], v[220:223]
    v_cndmask_b32 v69, v67, v69, vcc
    v_lshl_add_u32 v70, v69, 3, v70
    v_mfma_f32_16x16x32_bf16 v[140:143], v[112:115], a[80:83], v[140:143]
    buffer_load_dwordx4 v2, s[32:35], s58 offen offset:1024 sc1 lds
    ds_read_b128 v[92:95], v10 offset:48128
    v_mfma_f32_16x16x32_bf16 v[168:171], v[112:115], a[84:87], v[168:171]
    v_add3_u32 v14, v70, 32, s7
    v_add3_u32 v15, v70, 32, s8
    v_mfma_f32_16x16x32_bf16 v[196:199], v[112:115], a[88:91], v[196:199]
    ds_read_b128 v[96:99], v11 offset:43008
    v_lshl_add_u32 v70, v64, 3, v66
    v_mfma_f32_16x16x32_bf16 v[224:227], v[112:115], a[92:95], v[224:227]
    v_mul_u32_u24 v21, 48, v70
    v_lshl_add_u32 v21, v69, 3, v21
    v_mfma_f32_16x16x32_bf16 v[144:147], v[116:119], a[80:83], v[144:147]
    buffer_load_dwordx4 v2, s[32:35], s58 offen offset:2048 sc1 lds
    s_waitcnt vmcnt(16)
    ds_read_b128 a[96:99], v8 offset:0
    v_mfma_f32_16x16x32_bf16 v[172:175], v[116:119], a[84:87], v[172:175]
    v_add_u32 v21, s4, v21
    v_mul_u32_u24 v70, 80, v70
    v_mfma_f32_16x16x32_bf16 v[200:203], v[116:119], a[88:91], v[200:203]
    ds_read_b128 a[100:103], v8 offset:2048
    v_add_u32 v70, s4, v70
    v_mfma_f32_16x16x32_bf16 v[228:231], v[116:119], a[92:95], v[228:231]
    s_waitcnt lgkmcnt(6)
    v_max3_u32 v33, v72, v76, v80
    v_and_b32 v69, 1, v67
    v_mfma_f32_16x16x32_bf16 v[148:151], v[120:123], a[80:83], v[148:151]
    s_mov_b32 exec_hi, 0
    buffer_load_dwordx4 v2, s[32:35], s58 offen offset:3072 sc1 lds
    s_mov_b32 exec_hi, -1
    v_mfma_f32_16x16x32_bf16 v[176:179], v[120:123], a[84:87], v[176:179]
    ds_read_b128 a[104:107], v8 offset:4096
    s_waitcnt lgkmcnt(5)
    v_max3_u32 v33, v84, v88, v33
    v_mfma_f32_16x16x32_bf16 v[204:207], v[120:123], a[88:91], v[204:207]
    s_waitcnt lgkmcnt(3)
    v_max3_u32 v33, v92, v96, v33
    s_add_u32 s63, s63, 14336
    v_mfma_f32_16x16x32_bf16 v[232:235], v[120:123], a[92:95], v[232:235]
    ds_read_b128 a[108:111], v8 offset:6144
    v_cmp_eq_u32 s[96:97], -1, v33
    v_mfma_f32_16x16x32_bf16 v[152:155], v[124:127], a[80:83], v[152:155]
    s_cmp_lg_u64 s[96:97], 0
    s_cbranch_scc1 REC6
BK6:
    v_mfma_f32_16x16x32_bf16 v[180:183], v[124:127], a[84:87], v[180:183]
    ds_read_b128 a[112:115], v9 offset:0
    v_lshl_add_u32 v20, v69, 3, v70
    v_mfma_f32_16x16x32_bf16 v[208:211], v[124:127], a[88:91], v[208:211]
    s_cmp_eq_u32 s63, 129024
    s_cselect_b32 s63, 0, s63
    v_mfma_f32_16x16x32_bf16 v[236:239], v[124:127], a[92:95], v[236:239]
    ds_read_b128 a[116:119], v9 offset:2048
    s_add_u32 s58, s50, s48
    s_waitcnt lgkmcnt(5)
    v_mfma_f32_16x16x32_bf16 v[128:131], v[72:75], a[96:99], v[128:131]
    s_add_u32 m0, s101, 16384
    v_lshl_add_u32 v19, v69, 5, v70
    s_waitcnt lgkmcnt(4)
    v_mfma_f32_16x16x32_bf16 v[156:159], v[72:75], a[100:103], v[156:159]
    buffer_load_dwordx4 v4, s[28:31], s58 offen offset:0 lds
    s_waitcnt lgkmcnt(3)
    v_mfma_f32_16x16x32_bf16 v[184:187], v[72:75], a[104:107], v[184:187]
    ds_read_b128 v[100:103], v10 offset:50176
    v_lshl_add_u32 v19, v68, 4, v19
    s_waitcnt lgkmcnt(3)
    v_mfma_f32_16x16x32_bf16 v[212:215], v[72:75], a[108:111], v[212:215]
    v_lshrrev_b32 v69, 1, v67
    v_lshl_add_u32 v19, v69, 3, v19
    v_mfma_f32_16x16x32_bf16 v[132:135], v[76:79], a[96:99], v[132:135]
    ds_read_b128 v[104:107], v10 offset:51200
    v_and_b32 v69, 15, v1
    v_mfma_f32_16x16x32_bf16 v[160:163], v[76:79], a[100:103], v[160:163]
    buffer_load_dwordx4 v5, s[28:31], s58 offen offset:1024 lds
    v_lshl_add_u32 v69, v64, 4, v69
    v_mfma_f32_16x16x32_bf16 v[188:191], v[76:79], a[104:107], v[188:191]
    ds_read_b128 v[108:111], v10 offset:52224
    v_lshlrev_b32 v69, 4, v69
    v_mfma_f32_16x16x32_bf16 v[216:219], v[76:79], a[108:111], v[216:219]
    v_mul_u32_u24 v0, 73728, v68
    v_add_u32 v0, v0, v69
    v_mfma_f32_16x16x32_bf16 v[136:139], v[80:83], a[96:99], v[136:139]
    ds_read_b128 v[112:115], v10 offset:53248
    v_min_u32 v65, 23, v65
    v_mfma_f32_16x16x32_bf16 v[164:167], v[80:83], a[100:103], v[164:167]
    buffer_load_dwordx4 v6, s[28:31], s58 offen offset:2048 lds
    v_lshl_add_u32 v69, v64, 5, v65
    v_mfma_f32_16x16x32_bf16 v[192:195], v[80:83], a[104:107], v[192:195]
    ds_read_b128 v[116:119], v10 offset:54272
    v_lshlrev_b32 v69, 4, v69
    v_mfma_f32_16x16x32_bf16 v[220:223], v[80:83], a[108:111], v[220:223]
    v_add_u32 v38, 73728, v69
    v_bfe_u32 v69, v65, 1, 2
    v_mfma_f32_16x16x32_bf16 v[140:143], v[84:87], a[96:99], v[140:143]
    ds_read_b128 v[120:123], v10 offset:55296
    v_lshl_add_u32 v69, v64, 5, v69
    v_mfma_f32_16x16x32_bf16 v[168:171], v[84:87], a[100:103], v[168:171]
    buffer_load_dwordx4 v7, s[28:31], s58 offen offset:3072 lds
    s_movk_i32 s13, 384
    v_mfma_f32_16x16x32_bf16 v[196:199], v[84:87], a[104:107], v[196:199]
    ds_read_b128 v[124:127], v11 offset:50176
    s_add_u32 s58, s50, s49
    v_mfma_f32_16x16x32_bf16 v[224:227], v[84:87], a[108:111], v[224:227]
    s_add_u32 m0, s101, 20480
    v_lshl_add_u32 v69, v69, 4, s13
    v_mfma_f32_16x16x32_bf16 v[144:147], v[88:91], a[96:99], v[144:147]
    ds_read_b128 a[120:123], v9 offset:4096
    v_and_b32 v70, 1, v65
    v_mfma_f32_16x16x32_bf16 v[172:175], v[88:91], a[100:103], v[172:175]
    buffer_load_dwordx4 v4, s[28:31], s58 offen offset:0 lds
    v_mfma_f32_16x16x32_bf16 v[200:203], v[88:91], a[104:107], v[200:203]
    ds_read_b128 a[124:127], v9 offset:6144
    v_lshl_add_u32 v39, v70, 2, v69
    v_mfma_f32_16x16x32_bf16 v[228:231], v[88:91], a[108:111], v[228:231]
    s_waitcnt lgkmcnt(6)
    v_max3_u32 v33, v100, v104, v108
    v_lshl_add_u32 v69, v70, 3, v69
    v_mfma_f32_16x16x32_bf16 v[148:151], v[92:95], a[96:99], v[148:151]
    s_waitcnt lgkmcnt(4)
    v_max3_u32 v33, v112, v116, v33
    v_lshrrev_b32 v70, 3, v65
    v_mfma_f32_16x16x32_bf16 v[176:179], v[92:95], a[100:103], v[176:179]
    buffer_load_dwordx4 v5, s[28:31], s58 offen offset:1024 lds
    s_waitcnt lgkmcnt(2)
    v_max3_u32 v33, v120, v124, v33
    v_mfma_f32_16x16x32_bf16 v[204:207], v[92:95], a[104:107], v[204:207]
    v_cmp_eq_u32 s[96:97], -1, v33
    v_lshl_add_u32 v69, v70, 10, v69
    v_mfma_f32_16x16x32_bf16 v[232:235], v[92:95], a[108:111], v[232:235]
    s_cmp_lg_u64 s[96:97], 0
    s_cbranch_scc1 REC7
BK7:
    v_mfma_f32_16x16x32_bf16 v[152:155], v[96:99], a[96:99], v[152:155]
    v_add_u32 v3, s4, v69
    v_and_b32 v69, 1, v70
    v_mfma_f32_16x16x32_bf16 v[180:183], v[96:99], a[100:103], v[180:183]
    buffer_load_dwordx4 v6, s[28:31], s58 offen offset:2048 lds
    v_lshl_add_u32 v39, v69, 3, v39
    v_mfma_f32_16x16x32_bf16 v[208:211], v[96:99], a[104:107], v[208:211]
    v_lshrrev_b32 v70, 1, v70
    v_lshl_add_u32 v39, v70, 10, v39
    v_mfma_f32_16x16x32_bf16 v[236:239], v[96:99], a[108:111], v[236:239]
    v_add_u32 v39, 73728, v39
    s_lshr_b32 s16, s52, 1
    v_mfma_f32_16x16x32_bf16 v[128:131], v[100:103], a[112:115], v[128:131]
    s_lshl_b32 s6, s16, 10
    s_and_b32 s16, s52, 1
    v_mfma_f32_16x16x32_bf16 v[156:159], v[100:103], a[116:119], v[156:159]
    s_barrier
    s_waitcnt lgkmcnt(1)
    v_mfma_f32_16x16x32_bf16 v[184:187], v[100:103], a[120:123], v[184:187]
    buffer_load_dwordx4 v7, s[28:31], s58 offen offset:3072 lds
    ds_read_b128 v[72:75], v10 offset:0
    s_waitcnt lgkmcnt(1)
    v_mfma_f32_16x16x32_bf16 v[212:215], v[100:103], a[124:127], v[212:215]
    s_add_u32 s50, s50, 128
    s_lshl_b32 s16, s16, 3
    v_mfma_f32_16x16x32_bf16 v[132:135], v[104:107], a[112:115], v[132:135]
    ds_read_b128 v[76:79], v10 offset:1024
    s_add_u32 s6, s6, s16
    v_mfma_f32_16x16x32_bf16 v[160:163], v[104:107], a[116:119], v[160:163]
    s_cmp_eq_u32 s50, 1152
    s_cselect_b32 s50, 0, s50
    v_mfma_f32_16x16x32_bf16 v[188:191], v[104:107], a[120:123], v[188:191]
    ds_read_b128 v[80:83], v10 offset:2048
    s_add_u32 s58, s63, s51
    v_mfma_f32_16x16x32_bf16 v[216:219], v[104:107], a[124:127], v[216:219]
    s_add_u32 m0, s62, 141312
    s_add_u32 s6, s6, 73728
    v_mfma_f32_16x16x32_bf16 v[136:139], v[108:111], a[112:115], v[136:139]
    buffer_load_dwordx4 v2, s[32:35], s58 offen offset:0 sc1 lds
    ds_read_b128 v[84:87], v10 offset:3072
    v_mfma_f32_16x16x32_bf16 v[164:167], v[108:111], a[116:119], v[164:167]
    s_lshl_b32 s16, s54, 2
    s_add_u32 s16, s16, s52
    v_mfma_f32_16x16x32_bf16 v[192:195], v[108:111], a[120:123], v[192:195]
    ds_read_b128 v[88:91], v10 offset:4096
    s_lshl_b32 s43, s54, 10
    v_mfma_f32_16x16x32_bf16 v[220:223], v[108:111], a[124:127], v[220:223]
    s_add_u32 s43, s43, s40
    s_lshl_b32 s16, s16, 3
    v_mfma_f32_16x16x32_bf16 v[140:143], v[112:115], a[112:115], v[140:143]
    buffer_load_dwordx4 v2, s[32:35], s58 offen offset:1024 sc1 lds
    ds_read_b128 v[92:95], v10 offset:5120
    v_mfma_f32_16x16x32_bf16 v[168:171], v[112:115], a[116:119], v[168:171]
    s_lshr_b32 s17, s53, 3
    s_add_u32 s16, s16, s17
    v_mfma_f32_16x16x32_bf16 v[196:199], v[112:115], a[120:123], v[196:199]
    ds_read_b128 v[96:99], v11 offset:0
    s_mul_i32 s16, s16, 18432
    v_mfma_f32_16x16x32_bf16 v[224:227], v[112:115], a[124:127], v[224:227]
    s_add_u32 s16, s16, 14680064
    s_and_b32 s17, s53, 7
    v_mfma_f32_16x16x32_bf16 v[144:147], v[116:119], a[112:115], v[144:147]
    buffer_load_dwordx4 v2, s[32:35], s58 offen offset:2048 sc1 lds
    s_waitcnt vmcnt(15)
    ds_read_b128 a[128:131], v8 offset:8192
    v_mfma_f32_16x16x32_bf16 v[172:175], v[116:119], a[116:119], v[172:175]
    s_lshl_b32 s11, s17, 7
    s_add_u32 s11, s11, s16
    v_mfma_f32_16x16x32_bf16 v[200:203], v[116:119], a[120:123], v[200:203]
    ds_read_b128 a[132:135], v8 offset:10240
    s_add_u32 s11, s11, 12288
    v_mfma_f32_16x16x32_bf16 v[228:231], v[116:119], a[124:127], v[228:231]
    s_waitcnt lgkmcnt(6)
    v_max3_u32 v33, v72, v76, v80
    s_lshl_b32 s17, s17, 9
    v_mfma_f32_16x16x32_bf16 v[148:151], v[120:123], a[112:115], v[148:151]
    s_mov_b32 exec_hi, 0
    buffer_load_dwordx4 v2, s[32:35], s58 offen offset:3072 sc1 lds
    s_mov_b32 exec_hi, -1
    v_mfma_f32_16x16x32_bf16 v[176:179], v[120:123], a[116:119], v[176:179]
    ds_read_b128 a[136:139], v8 offset:12288
    s_waitcnt lgkmcnt(5)
    v_max3_u32 v33, v84, v88, v33
    v_mfma_f32_16x16x32_bf16 v[204:207], v[120:123], a[120:123], v[204:207]
    s_waitcnt lgkmcnt(3)
    v_max3_u32 v33, v92, v96, v33
    s_add_u32 s63, s63, 14336
    v_mfma_f32_16x16x32_bf16 v[232:235], v[120:123], a[124:127], v[232:235]
    ds_read_b128 a[140:143], v8 offset:14336
    v_cmp_eq_u32 s[96:97], -1, v33
    v_mfma_f32_16x16x32_bf16 v[152:155], v[124:127], a[112:115], v[152:155]
    s_cmp_lg_u64 s[96:97], 0
    s_cbranch_scc1 REC8
BK8:
    v_mfma_f32_16x16x32_bf16 v[180:183], v[124:127], a[116:119], v[180:183]
    ds_read_b128 a[144:147], v9 offset:8192
    s_add_u32 s16, s16, s17
    v_mfma_f32_16x16x32_bf16 v[208:211], v[124:127], a[120:123], v[208:211]
    s_cmp_eq_u32 s63, 129024
    s_cselect_b32 s63, 0, s63
    v_mfma_f32_16x16x32_bf16 v[236:239], v[124:127], a[124:127], v[236:239]
    ds_read_b128 a[148:151], v9 offset:10240
    s_add_u32 s58, s50, s48
    s_waitcnt lgkmcnt(5)
    v_mfma_f32_16x16x32_bf16 v[128:131], v[72:75], a[128:131], v[128:131]
    s_add_u32 m0, s101, 0
    s_add_u32 s42, s16, 8192
    s_waitcnt lgkmcnt(4)
    v_mfma_f32_16x16x32_bf16 v[156:159], v[72:75], a[132:135], v[156:159]
    buffer_load_dwordx4 v4, s[28:31], s58 offen offset:0 lds
    s_waitcnt lgkmcnt(3)
    v_mfma_f32_16x16x32_bf16 v[184:187], v[72:75], a[136:139], v[184:187]
    ds_read_b128 v[100:103], v10 offset:7168
    s_and_b32 s17, s17, 0xc00
    s_waitcnt lgkmcnt(3)
    v_mfma_f32_16x16x32_bf16 v[212:215], v[72:75], a[140:143], v[212:215]
    s_add_u32 s41, s16, s17
    s_and_b32 s16, s3, 7
    v_mfma_f32_16x16x32_bf16 v[132:135], v[76:79], a[128:131], v[132:135]
    ds_read_b128 v[104:107], v10 offset:8192
    s_lshl_b32 s17, s16, 4
    v_mfma_f32_16x16x32_bf16 v[160:163], v[76:79], a[132:135], v[160:163]
    buffer_load_dwordx4 v5, s[28:31], s58 offen offset:1024 lds
    s_add_u32 s17, s17, s55
    v_mfma_f32_16x16x32_bf16 v[188:191], v[76:79], a[136:139], v[188:191]
    ds_read_b128 v[108:111], v10 offset:9216
    s_mul_i32 s10, s17, 18432
    v_mfma_f32_16x16x32_bf16 v[216:219], v[76:79], a[140:143], v[216:219]
    s_xor_b32 s17, s17, 14
    s_mul_i32 s0, s17, 18432
    v_mfma_f32_16x16x32_bf16 v[136:139], v[80:83], a[128:131], v[136:139]
    ds_read_b128 v[112:115], v10 offset:10240
    s_lshl_b32 s17, s16, 3
    v_mfma_f32_16x16x32_bf16 v[164:167], v[80:83], a[132:135], v[164:167]
    buffer_load_dwordx4 v6, s[28:31], s58 offen offset:2048 lds
    s_add_u32 s17, s17, s55
    v_mfma_f32_16x16x32_bf16 v[192:195], v[80:83], a[136:139], v[192:195]
    ds_read_b128 v[116:119], v10 offset:11264
    s_lshr_b32 s16, s17, 1
    v_mfma_f32_16x16x32_bf16 v[220:223], v[80:83], a[140:143], v[220:223]
    s_lshl_b32 s17, s17, 2
    s_add_u32 s17, s17, s52
    v_mfma_f32_16x16x32_bf16 v[140:143], v[84:87], a[128:131], v[140:143]
    ds_read_b128 v[120:123], v10 offset:12288
    s_mul_i32 s18, s17, 18432
    v_mfma_f32_16x16x32_bf16 v[168:171], v[84:87], a[132:135], v[168:171]
    buffer_load_dwordx4 v7, s[28:31], s58 offen offset:3072 lds
    s_add_u32 s18, s18, 14680064
    v_mfma_f32_16x16x32_bf16 v[196:199], v[84:87], a[136:139], v[196:199]
    ds_read_b128 v[124:127], v11 offset:7168
    s_add_u32 s58, s50, s49
    v_mfma_f32_16x16x32_bf16 v[224:227], v[84:87], a[140:143], v[224:227]
    s_add_u32 m0, s101, 4096
    s_lshl_b32 s16, s16, 2
    v_mfma_f32_16x16x32_bf16 v[144:147], v[88:91], a[128:131], v[144:147]
    ds_read_b128 a[152:155], v9 offset:12288
    s_add_u32 s16, s16, s52
    v_mfma_f32_16x16x32_bf16 v[172:175], v[88:91], a[132:135], v[172:175]
    buffer_load_dwordx4 v4, s[28:31], s58 offen offset:0 lds
    v_mfma_f32_16x16x32_bf16 v[200:203], v[88:91], a[136:139], v[200:203]
    ds_read_b128 a[156:159], v9 offset:14336
    s_lshl_b32 s16, s16, 6
    v_mfma_f32_16x16x32_bf16 v[228:231], v[88:91], a[140:143], v[228:231]
    s_waitcnt lgkmcnt(6)
    v_max3_u32 v33, v100, v104, v108
    s_add_u32 s19, s16, 49152
    v_mfma_f32_16x16x32_bf16 v[148:151], v[92:95], a[128:131], v[148:151]
    s_waitcnt lgkmcnt(4)
    v_max3_u32 v33, v112, v116, v33
    s_bfe_u32 s16, s3, 0x20003
    v_mfma_f32_16x16x32_bf16 v[176:179], v[92:95], a[132:135], v[176:179]
    buffer_load_dwordx4 v5, s[28:31], s58 offen offset:1024 lds
    s_waitcnt lgkmcnt(2)
    v_max3_u32 v33, v120, v124, v33
    v_mfma_f32_16x16x32_bf16 v[204:207], v[92:95], a[136:139], v[204:207]
    v_cmp_eq_u32 s[96:97], -1, v33
    s_mul_i32 s17, s16, 288
    v_mfma_f32_16x16x32_bf16 v[232:235], v[92:95], a[140:143], v[232:235]
    s_cmp_lg_u64 s[96:97], 0
    s_cbranch_scc1 REC9
BK9:
    v_mfma_f32_16x16x32_bf16 v[152:155], v[96:99], a[128:131], v[152:155]
    s_add_u32 s10, s10, s17
    s_add_u32 s0, s0, s17
    v_mfma_f32_16x16x32_bf16 v[180:183], v[96:99], a[132:135], v[180:183]
    buffer_load_dwordx4 v6, s[28:31], s58 offen offset:2048 lds
    s_lshl_b32 s16, s16, 2
    v_mfma_f32_16x16x32_bf16 v[208:211], v[96:99], a[136:139], v[208:211]
    s_add_u32 s16, s16, s52
    s_lshl_b32 s9, s16, 9
    v_mfma_f32_16x16x32_bf16 v[236:239], v[96:99], a[140:143], v[236:239]
    s_add_u32 s9, s9, 40960
    s_mul_i32 s2, s16, 82944
    v_mfma_f32_16x16x32_bf16 v[128:131], v[100:103], a[144:147], v[128:131]
    s_add_u32 s2, s2, 4194304
    v_and_b32 v22, 31, v1
    v_mfma_f32_16x16x32_bf16 v[156:159], v[100:103], a[148:151], v[156:159]
    s_barrier
    s_waitcnt lgkmcnt(1)
    v_mfma_f32_16x16x32_bf16 v[184:187], v[100:103], a[152:155], v[184:187]
    buffer_load_dwordx4 v7, s[28:31], s58 offen offset:3072 lds
    ds_read_b128 v[72:75], v10 offset:14336
    s_waitcnt lgkmcnt(1)
    v_mfma_f32_16x16x32_bf16 v[212:215], v[100:103], a[156:159], v[212:215]
    s_add_u32 s50, s50, 128
    v_lshlrev_b32 v64, 2, v64
    v_mfma_f32_16x16x32_bf16 v[132:135], v[104:107], a[144:147], v[132:135]
    ds_read_b128 v[76:79], v10 offset:15360
    v_sub_u32 v22, v22, v64
    v_mfma_f32_16x16x32_bf16 v[160:163], v[104:107], a[148:151], v[160:163]
    s_cmp_eq_u32 s50, 1152
    s_cselect_b32 s50, 0, s50
    v_mfma_f32_16x16x32_bf16 v[188:191], v[104:107], a[152:155], v[188:191]
    ds_read_b128 v[80:83], v10 offset:16384
    s_add_u32 s58, s63, s51
    v_mfma_f32_16x16x32_bf16 v[216:219], v[104:107], a[156:159], v[216:219]
    s_add_u32 m0, s62, 98304
    v_mov_b32 v26, 0xff800000
    v_mfma_f32_16x16x32_bf16 v[136:139], v[108:111], a[144:147], v[136:139]
    buffer_load_dwordx4 v2, s[32:35], s58 offen offset:0 sc1 lds
    ds_read_b128 v[84:87], v10 offset:17408
    v_mfma_f32_16x16x32_bf16 v[164:167], v[108:111], a[148:151], v[164:167]
    v_cmp_gt_i32 vcc, 0, v22
    v_mov_b32 v30, 0x3f803f80
    v_mfma_f32_16x16x32_bf16 v[192:195], v[108:111], a[152:155], v[192:195]
    ds_read_b128 v[88:91], v10 offset:18432
    v_cndmask_b32 v40, 0, v26, vcc
    v_mfma_f32_16x16x32_bf16 v[220:223], v[108:111], a[156:159], v[220:223]
    v_cmp_gt_i32 vcc, 1, v22
    v_xor_b32 v56, v26, v40
    v_mfma_f32_16x16x32_bf16 v[140:143], v[112:115], a[144:147], v[140:143]
    buffer_load_dwordx4 v2, s[32:35], s58 offen offset:1024 sc1 lds
    ds_read_b128 v[92:95], v10 offset:19456
    v_mfma_f32_16x16x32_bf16 v[168:171], v[112:115], a[148:151], v[168:171]
    v_cndmask_b32 v41, 0, v26, vcc
    v_cmp_gt_i32 vcc, 2, v22
    v_mfma_f32_16x16x32_bf16 v[196:199], v[112:115], a[152:155], v[196:199]
    ds_read_b128 v[96:99], v11 offset:14336
    v_xor_b32 v57, v26, v41
    v_mfma_f32_16x16x32_bf16 v[224:227], v[112:115], a[156:159], v[224:227]
    v_cndmask_b32 v42, 0, v26, vcc
    v_cmp_gt_i32 vcc, 3, v22
    v_mfma_f32_16x16x32_bf16 v[144:147], v[116:119], a[144:147], v[144:147]
    buffer_load_dwordx4 v2, s[32:35], s58 offen offset:2048 sc1 lds
    s_waitcnt vmcnt(15)
    ds_read_b128 a[160:163], v8 offset:16384
    v_mfma_f32_16x16x32_bf16 v[172:175], v[116:119], a[148:151], v[172:175]
    v_xor_b32 v58, v26, v42
    v_cndmask_b32 v43, 0, v26, vcc
    v_mfma_f32_16x16x32_bf16 v[200:203], v[116:119], a[152:155], v[200:203]
    ds_read_b128 a[164:167], v8 offset:18432
    v_cmp_gt_i32 vcc, 8, v22
    v_mfma_f32_16x16x32_bf16 v[228:231], v[116:119], a[156:159], v[228:231]
    s_waitcnt lgkmcnt(6)
    v_max3_u32 v33, v72, v76, v80
    v_xor_b32 v59, v26, v43
    v_mfma_f32_16x16x32_bf16 v[148:151], v[120:123], a[144:147], v[148:151]
    s_mov_b32 exec_hi, 0
    buffer_load_dwordx4 v2, s[32:35], s58 offen offset:3072 sc1 lds
    s_mov_b32 exec_hi, -1
    v_mfma_f32_16x16x32_bf16 v[176:179], v[120:123], a[148:151], v[176:179]
    ds_read_b128 a[168:171], v8 offset:20480
    s_waitcnt lgkmcnt(5)
    v_max3_u32 v33, v84, v88, v33
    v_mfma_f32_16x16x32_bf16 v[204:207], v[120:123], a[152:155], v[204:207]
    s_waitcnt lgkmcnt(3)
    v_max3_u32 v33, v92, v96, v33
    s_add_u32 s58, s50, s48
    v_mfma_f32_16x16x32_bf16 v[232:235], v[120:123], a[156:159], v[232:235]
    ds_read_b128 a[172:175], v8 offset:22528
    v_cmp_eq_u32 s[96:97], -1, v33
    v_mfma_f32_16x16x32_bf16 v[152:155], v[124:127], a[144:147], v[152:155]
    s_cmp_lg_u64 s[96:97], 0
    s_cbranch_scc1 REC10
BK10:
    v_mfma_f32_16x16x32_bf16 v[180:183], v[124:127], a[148:151], v[180:183]
    ds_read_b128 a[176:179], v9 offset:16384
    s_add_u32 m0, s101, 8192
    v_mfma_f32_16x16x32_bf16 v[208:211], v[124:127], a[152:155], v[208:211]
    buffer_load_dwordx4 v4, s[28:31], s58 offen offset:0 lds
    v_mfma_f32_16x16x32_bf16 v[236:239], v[124:127], a[156:159], v[236:239]
    ds_read_b128 a[180:183], v9 offset:18432
    v_cndmask_b32 v44, 0, v26, vcc
    s_waitcnt lgkmcnt(5)
    v_mfma_f32_16x16x32_bf16 v[128:131], v[72:75], a[160:163], v[128:131]
    v_cmp_gt_i32 vcc, 9, v22
    v_xor_b32 v60, v26, v44
    s_waitcnt lgkmcnt(4)
    v_mfma_f32_16x16x32_bf16 v[156:159], v[72:75], a[164:167], v[156:159]
    ds_read_b128 v[100:103], v10 offset:21504
    v_cndmask_b32 v45, 0, v26, vcc
    s_waitcnt lgkmcnt(4)
    v_mfma_f32_16x16x32_bf16 v[184:187], v[72:75], a[168:171], v[184:187]
    buffer_load_dwordx4 v5, s[28:31], s58 offen offset:1024 lds
    v_cmp_gt_i32 vcc, 10, v22
    s_waitcnt lgkmcnt(3)
    v_mfma_f32_16x16x32_bf16 v[212:215], v[72:75], a[172:175], v[212:215]
    ds_read_b128 v[104:107], v10 offset:22528
    v_xor_b32 v61, v26, v45
    v_mfma_f32_16x16x32_bf16 v[132:135], v[76:79], a[160:163], v[132:135]
    v_cndmask_b32 v46, 0, v26, vcc
    v_cmp_gt_i32 vcc, 11, v22
    v_mfma_f32_16x16x32_bf16 v[160:163], v[76:79], a[164:167], v[160:163]
    ds_read_b128 v[108:111], v10 offset:23552
    v_xor_b32 v62, v26, v46
    v_mfma_f32_16x16x32_bf16 v[188:191], v[76:79], a[168:171], v[188:191]
    buffer_load_dwordx4 v6, s[28:31], s58 offen offset:2048 lds
    v_cndmask_b32 v47, 0, v26, vcc
    v_mfma_f32_16x16x32_bf16 v[216:219], v[76:79], a[172:175], v[216:219]
    ds_read_b128 v[112:115], v10 offset:24576
    v_cmp_gt_i32 vcc, 16, v22
    v_mfma_f32_16x16x32_bf16 v[136:139], v[80:83], a[160:163], v[136:139]
    v_xor_b32 v63, v26, v47
    v_cndmask_b32 v48, 0, v26, vcc
    v_mfma_f32_16x16x32_bf16 v[164:167], v[80:83], a[164:167], v[164:167]
    ds_read_b128 v[116:119], v10 offset:25600
    v_cmp_gt_i32 vcc, 17, v22
    v_mfma_f32_16x16x32_bf16 v[192:195], v[80:83], a[168:171], v[192:195]
    buffer_load_dwordx4 v7, s[28:31], s58 offen offset:3072 lds
    v_xor_b32 v64, v26, v48
    v_mfma_f32_16x16x32_bf16 v[220:223], v[80:83], a[172:175], v[220:223]
    ds_read_b128 v[120:123], v10 offset:26624
    s_add_u32 s58, s50, s49
    v_mfma_f32_16x16x32_bf16 v[140:143], v[84:87], a[160:163], v[140:143]
    s_add_u32 m0, s101, 12288
    v_cndmask_b32 v49, 0, v26, vcc
    v_mfma_f32_16x16x32_bf16 v[168:171], v[84:87], a[164:167], v[168:171]
    ds_read_b128 v[124:127], v11 offset:21504
    v_cmp_gt_i32 vcc, 18, v22
    v_mfma_f32_16x16x32_bf16 v[196:199], v[84:87], a[168:171], v[196:199]
    buffer_load_dwordx4 v4, s[28:31], s58 offen offset:0 lds
    v_mfma_f32_16x16x32_bf16 v[224:227], v[84:87], a[172:175], v[224:227]
    ds_read_b128 a[184:187], v9 offset:20480
    v_xor_b32 v65, v26, v49
    v_mfma_f32_16x16x32_bf16 v[144:147], v[88:91], a[160:163], v[144:147]
    v_cndmask_b32 v50, 0, v26, vcc
    v_cmp_gt_i32 vcc, 19, v22
    v_mfma_f32_16x16x32_bf16 v[172:175], v[88:91], a[164:167], v[172:175]
    ds_read_b128 a[188:191], v9 offset:22528
    v_xor_b32 v66, v26, v50
    v_mfma_f32_16x16x32_bf16 v[200:203], v[88:91], a[168:171], v[200:203]
    buffer_load_dwordx4 v5, s[28:31], s58 offen offset:1024 lds
    s_waitcnt lgkmcnt(6)
    v_max3_u32 v33, v100, v104, v108
    v_mfma_f32_16x16x32_bf16 v[228:231], v[88:91], a[172:175], v[228:231]
    s_waitcnt vmcnt(10)
    ds_read_b128 a[192:195], v8 offset:0
    s_waitcnt lgkmcnt(5)
    v_max3_u32 v33, v112, v116, v33
    v_mfma_f32_16x16x32_bf16 v[148:151], v[92:95], a[160:163], v[148:151]
    s_waitcnt lgkmcnt(3)
    v_max3_u32 v33, v120, v124, v33
    v_cndmask_b32 v51, 0, v26, vcc
    v_mfma_f32_16x16x32_bf16 v[176:179], v[92:95], a[164:167], v[176:179]
    ds_read_b128 a[196:199], v8 offset:2048
    v_cmp_eq_u32 s[96:97], -1, v33
    v_mfma_f32_16x16x32_bf16 v[204:207], v[92:95], a[168:171], v[204:207]
    buffer_load_dwordx4 v6, s[28:31], s58 offen offset:2048 lds
    v_cmp_gt_i32 vcc, 24, v22
    v_mfma_f32_16x16x32_bf16 v[232:235], v[92:95], a[172:175], v[232:235]
    ds_read_b128 a[200:203], v8 offset:4096
    v_xor_b32 v67, v26, v51
    v_mfma_f32_16x16x32_bf16 v[152:155], v[96:99], a[160:163], v[152:155]
    s_cmp_lg_u64 s[96:97], 0
    s_cbranch_scc1 REC11
BK11:
    v_mfma_f32_16x16x32_bf16 v[180:183], v[96:99], a[164:167], v[180:183]
    ds_read_b128 a[204:207], v8 offset:6144
    v_cndmask_b32 v52, 0, v26, vcc
    v_mfma_f32_16x16x32_bf16 v[208:211], v[96:99], a[168:171], v[208:211]
    buffer_load_dwordx4 v7, s[28:31], s58 offen offset:3072 lds
    s_add_u32 s50, s50, 128
    v_mfma_f32_16x16x32_bf16 v[236:239], v[96:99], a[172:175], v[236:239]
    ds_read_b128 a[208:211], v9 offset:0
    v_cmp_gt_i32 vcc, 25, v22
    v_mfma_f32_16x16x32_bf16 v[128:131], v[100:103], a[176:179], v[128:131]
    s_cmp_eq_u32 s50, 1152
    s_cselect_b32 s50, 0, s50
    v_mfma_f32_16x16x32_bf16 v[156:159], v[100:103], a[180:183], v[156:159]
    s_barrier
    s_waitcnt lgkmcnt(6)
    v_mfma_f32_16x16x32_bf16 v[184:187], v[100:103], a[184:187], v[184:187]
    ds_read_b128 v[72:75], v10 offset:28672
    s_add_u32 s58, s50, s48
    s_waitcnt lgkmcnt(6)
    v_mfma_f32_16x16x32_bf16 v[212:215], v[100:103], a[188:191], v[212:215]
    s_add_u32 m0, s101, 16384
    v_xor_b32 v68, v26, v52
    v_mfma_f32_16x16x32_bf16 v[132:135], v[104:107], a[176:179], v[132:135]
    buffer_load_dwordx4 v4, s[28:31], s58 offen offset:0 lds
    v_mfma_f32_16x16x32_bf16 v[160:163], v[104:107], a[180:183], v[160:163]
    ds_read_b128 v[76:79], v10 offset:29696
    v_cndmask_b32 v53, 0, v26, vcc
    v_mfma_f32_16x16x32_bf16 v[188:191], v[104:107], a[184:187], v[188:191]
    v_cmp_gt_i32 vcc, 26, v22
    v_xor_b32 v69, v26, v53
    v_mfma_f32_16x16x32_bf16 v[216:219], v[104:107], a[188:191], v[216:219]
    ds_read_b128 v[80:83], v10 offset:30720
    v_cndmask_b32 v54, 0, v26, vcc
    v_mfma_f32_16x16x32_bf16 v[136:139], v[108:111], a[176:179], v[136:139]
    buffer_load_dwordx4 v5, s[28:31], s58 offen offset:1024 lds
    v_cmp_gt_i32 vcc, 27, v22
    v_mfma_f32_16x16x32_bf16 v[164:167], v[108:111], a[180:183], v[164:167]
    ds_read_b128 v[84:87], v10 offset:31744
    v_xor_b32 v70, v26, v54
    v_mfma_f32_16x16x32_bf16 v[192:195], v[108:111], a[184:187], v[192:195]
    v_cndmask_b32 v55, 0, v26, vcc
    v_xor_b32 v71, v26, v55
    v_mfma_f32_16x16x32_bf16 v[220:223], v[108:111], a[188:191], v[220:223]
    ds_read_b128 v[88:91], v10 offset:32768
    v_mfma_f32_16x16x32_bf16 v[140:143], v[112:115], a[176:179], v[140:143]
    buffer_load_dwordx4 v6, s[28:31], s58 offen offset:2048 lds
    v_mfma_f32_16x16x32_bf16 v[168:171], v[112:115], a[180:183], v[168:171]
    ds_read_b128 v[92:95], v10 offset:33792
    v_mfma_f32_16x16x32_bf16 v[196:199], v[112:115], a[184:187], v[196:199]
    v_mfma_f32_16x16x32_bf16 v[224:227], v[112:115], a[188:191], v[224:227]
    ds_read_b128 v[96:99], v11 offset:28672
    v_mfma_f32_16x16x32_bf16 v[144:147], v[116:119], a[176:179], v[144:147]
    buffer_load_dwordx4 v7, s[28:31], s58 offen offset:3072 lds
    v_mfma_f32_16x16x32_bf16 v[172:175], v[116:119], a[180:183], v[172:175]
    ds_read_b128 a[212:215], v9 offset:2048
    s_add_u32 s58, s50, s49
    v_mfma_f32_16x16x32_bf16 v[200:203], v[116:119], a[184:187], v[200:203]
    s_add_u32 m0, s101, 20480
    v_mfma_f32_16x16x32_bf16 v[228:231], v[116:119], a[188:191], v[228:231]
    ds_read_b128 a[216:219], v9 offset:4096
    v_mfma_f32_16x16x32_bf16 v[148:151], v[120:123], a[176:179], v[148:151]
    buffer_load_dwordx4 v4, s[28:31], s58 offen offset:0 lds
    v_mfma_f32_16x16x32_bf16 v[176:179], v[120:123], a[180:183], v[176:179]
    ds_read_b128 a[220:223], v9 offset:6144
    s_waitcnt lgkmcnt(7)
    v_max3_u32 v33, v72, v76, v80
    v_mfma_f32_16x16x32_bf16 v[204:207], v[120:123], a[184:187], v[204:207]
    s_waitcnt lgkmcnt(5)
    v_max3_u32 v33, v84, v88, v33
    v_mfma_f32_16x16x32_bf16 v[232:235], v[120:123], a[188:191], v[232:235]
    s_waitcnt lgkmcnt(3)
    v_max3_u32 v33, v92, v96, v33
    v_mfma_f32_16x16x32_bf16 v[152:155], v[124:127], a[176:179], v[152:155]
    buffer_load_dwordx4 v5, s[28:31], s58 offen offset:1024 lds
    v_cmp_eq_u32 s[96:97], -1, v33
    v_mfma_f32_16x16x32_bf16 v[180:183], v[124:127], a[180:183], v[180:183]
    s_cmp_lg_u64 s[96:97], 0
    s_cbranch_scc1 REC12
BK12:
    v_mfma_f32_16x16x32_bf16 v[208:211], v[124:127], a[184:187], v[208:211]
    v_mfma_f32_16x16x32_bf16 v[236:239], v[124:127], a[188:191], v[236:239]
    v_mfma_f32_16x16x32_bf16 v[128:131], v[72:75], a[192:195], v[128:131]
    buffer_load_dwordx4 v6, s[28:31], s58 offen offset:2048 lds
    v_mfma_f32_16x16x32_bf16 v[156:159], v[72:75], a[196:199], v[156:159]
    ds_read_b128 v[100:103], v10 offset:35840
    v_mfma_f32_16x16x32_bf16 v[184:187], v[72:75], a[200:203], v[184:187]
    v_mfma_f32_16x16x32_bf16 v[212:215], v[72:75], a[204:207], v[212:215]
    ds_read_b128 v[104:107], v10 offset:36864
    v_mfma_f32_16x16x32_bf16 v[132:135], v[76:79], a[192:195], v[132:135]
    buffer_load_dwordx4 v7, s[28:31], s58 offen offset:3072 lds
    v_mfma_f32_16x16x32_bf16 v[160:163], v[76:79], a[196:199], v[160:163]
    ds_read_b128 v[108:111], v10 offset:37888
    v_mfma_f32_16x16x32_bf16 v[188:191], v[76:79], a[200:203], v[188:191]
    v_mfma_f32_16x16x32_bf16 v[216:219], v[76:79], a[204:207], v[216:219]
    ds_read_b128 v[112:115], v10 offset:38912
    v_mfma_f32_16x16x32_bf16 v[136:139], v[80:83], a[192:195], v[136:139]
    buffer_store_dwordx4 v[34:37], v0, s[32:35], s41 offen offset:0 sc1
    v_mfma_f32_16x16x32_bf16 v[164:167], v[80:83], a[196:199], v[164:167]
    ds_read_b128 v[116:119], v10 offset:39936
    v_mfma_f32_16x16x32_bf16 v[192:195], v[80:83], a[200:203], v[192:195]
    v_mfma_f32_16x16x32_bf16 v[220:223], v[80:83], a[204:207], v[220:223]
    ds_read_b128 v[120:123], v10 offset:40960
    v_mfma_f32_16x16x32_bf16 v[140:143], v[84:87], a[192:195], v[140:143]
    buffer_store_dwordx4 v[34:37], v0, s[32:35], s41 offen offset:1024 sc1
    v_mfma_f32_16x16x32_bf16 v[168:171], v[84:87], a[196:199], v[168:171]
    ds_read_b128 v[124:127], v11 offset:35840
    v_mfma_f32_16x16x32_bf16 v[196:199], v[84:87], a[200:203], v[196:199]
    v_mfma_f32_16x16x32_bf16 v[224:227], v[84:87], a[204:207], v[224:227]
    s_waitcnt vmcnt(10)
    ds_read_b128 a[224:227], v8 offset:8192
    v_mfma_f32_16x16x32_bf16 v[144:147], v[88:91], a[192:195], v[144:147]
    buffer_store_dwordx4 v[34:37], v0, s[32:35], s42 offen offset:0 sc1
    v_mfma_f32_16x16x32_bf16 v[172:175], v[88:91], a[196:199], v[172:175]
    ds_read_b128 a[228:231], v8 offset:10240
    s_add_u32 s58, s42, 4096
    v_mfma_f32_16x16x32_bf16 v[200:203], v[88:91], a[200:203], v[200:203]
    s_waitcnt lgkmcnt(6)
    v_max3_u32 v33, v100, v104, v108
    v_mfma_f32_16x16x32_bf16 v[228:231], v[88:91], a[204:207], v[228:231]
    ds_read_b128 a[232:235], v8 offset:12288
    s_waitcnt lgkmcnt(5)
    v_max3_u32 v33, v112, v116, v33
    v_mfma_f32_16x16x32_bf16 v[148:151], v[92:95], a[192:195], v[148:151]
    buffer_store_dwordx4 v[34:37], v0, s[32:35], s58 offen offset:1024 sc1
    s_waitcnt lgkmcnt(3)
    v_max3_u32 v33, v120, v124, v33
    v_mfma_f32_16x16x32_bf16 v[176:179], v[92:95], a[196:199], v[176:179]
    ds_read_b128 a[236:239], v8 offset:14336
    v_cmp_eq_u32 s[96:97], -1, v33
    v_mfma_f32_16x16x32_bf16 v[204:207], v[92:95], a[200:203], v[204:207]
    s_cmp_lg_u64 s[96:97], 0
    s_cbranch_scc1 REC13
BK13:
    v_mfma_f32_16x16x32_bf16 v[232:235], v[92:95], a[204:207], v[232:235]
    ds_read_b128 a[240:243], v9 offset:8192
    v_min_u32 v6, 44, v1
    v_mfma_f32_16x16x32_bf16 v[152:155], v[96:99], a[192:195], v[152:155]
    v_lshlrev_b32 v6, 3, v6
    v_mfma_f32_16x16x32_bf16 v[180:183], v[96:99], a[196:199], v[180:183]
    buffer_load_dwordx2 v[4:5], v6, s[32:35], s9 offen sc1
    ds_read_b128 a[244:247], v9 offset:10240
    v_mfma_f32_16x16x32_bf16 v[208:211], v[96:99], a[200:203], v[208:211]
    v_mfma_f32_16x16x32_bf16 v[236:239], v[96:99], a[204:207], v[236:239]
    ds_read_b128 a[248:251], v9 offset:12288
    v_mfma_f32_16x16x32_bf16 v[128:131], v[100:103], a[208:211], v[128:131]
    v_mfma_f32_16x16x32_bf16 v[156:159], v[100:103], a[212:215], v[156:159]
    s_barrier
    v_mfma_f32_16x16x32_bf16 v[184:187], v[100:103], a[216:219], v[184:187]
    ds_read_b128 v[72:75], v10 offset:43008
    v_mfma_f32_16x16x32_bf16 v[212:215], v[100:103], a[220:223], v[212:215]
    v_mfma_f32_16x16x32_bf16 v[132:135], v[104:107], a[208:211], v[132:135]
    ds_read_b128 v[76:79], v10 offset:44032
    v_mfma_f32_16x16x32_bf16 v[160:163], v[104:107], a[212:215], v[160:163]
    v_mfma_f32_16x16x32_bf16 v[188:191], v[104:107], a[216:219], v[188:191]
    ds_read_b128 v[80:83], v10 offset:45056
    v_mfma_f32_16x16x32_bf16 v[216:219], v[104:107], a[220:223], v[216:219]
    v_mfma_f32_16x16x32_bf16 v[136:139], v[108:111], a[208:211], v[136:139]
    ds_read_b128 v[84:87], v10 offset:46080
    v_mfma_f32_16x16x32_bf16 v[164:167], v[108:111], a[212:215], v[164:167]
    v_mfma_f32_16x16x32_bf16 v[192:195], v[108:111], a[216:219], v[192:195]
    ds_read_b128 v[88:91], v10 offset:47104
    v_mfma_f32_16x16x32_bf16 v[220:223], v[108:111], a[220:223], v[220:223]
    v_mfma_f32_16x16x32_bf16 v[140:143], v[112:115], a[208:211], v[140:143]
    ds_read_b128 v[92:95], v10 offset:48128
    v_mfma_f32_16x16x32_bf16 v[168:171], v[112:115], a[212:215], v[168:171]
    v_mfma_f32_16x16x32_bf16 v[196:199], v[112:115], a[216:219], v[196:199]
    ds_read_b128 v[96:99], v11 offset:43008
    v_mfma_f32_16x16x32_bf16 v[224:227], v[112:115], a[220:223], v[224:227]
    v_mfma_f32_16x16x32_bf16 v[144:147], v[116:119], a[208:211], v[144:147]
    ds_read_b128 a[252:255], v9 offset:14336
    v_mfma_f32_16x16x32_bf16 v[172:175], v[116:119], a[212:215], v[172:175]
    v_mfma_f32_16x16x32_bf16 v[200:203], v[116:119], a[216:219], v[200:203]
    s_waitcnt vmcnt(5)
    ds_read_b128 a[0:3], v8 offset:16384
    v_mfma_f32_16x16x32_bf16 v[228:231], v[116:119], a[220:223], v[228:231]
    s_waitcnt lgkmcnt(6)
    v_max3_u32 v33, v72, v76, v80
    v_mfma_f32_16x16x32_bf16 v[148:151], v[120:123], a[208:211], v[148:151]
    ds_read_b128 a[4:7], v8 offset:18432
    s_waitcnt lgkmcnt(5)
    v_max3_u32 v33, v84, v88, v33
    v_mfma_f32_16x16x32_bf16 v[176:179], v[120:123], a[212:215], v[176:179]
    s_waitcnt lgkmcnt(3)
    v_max3_u32 v33, v92, v96, v33
    v_mfma_f32_16x16x32_bf16 v[204:207], v[120:123], a[216:219], v[204:207]
    ds_read_b128 a[8:11], v8 offset:20480
    v_cmp_eq_u32 s[96:97], -1, v33
    v_mfma_f32_16x16x32_bf16 v[232:235], v[120:123], a[220:223], v[232:235]
    s_cmp_lg_u64 s[96:97], 0
    s_cbranch_scc1 REC14
BK14:
    v_mfma_f32_16x16x32_bf16 v[152:155], v[124:127], a[208:211], v[152:155]
    ds_read_b128 a[12:15], v8 offset:22528
    v_mfma_f32_16x16x32_bf16 v[180:183], v[124:127], a[212:215], v[180:183]
    v_mfma_f32_16x16x32_bf16 v[208:211], v[124:127], a[216:219], v[208:211]
    ds_read_b128 a[16:19], v9 offset:16384
    v_mfma_f32_16x16x32_bf16 v[236:239], v[124:127], a[220:223], v[236:239]
    v_mfma_f32_16x16x32_bf16 v[128:131], v[72:75], a[224:227], v[128:131]
    v_mfma_f32_16x16x32_bf16 v[156:159], v[72:75], a[228:231], v[156:159]
    ds_read_b128 v[100:103], v10 offset:50176
    v_mfma_f32_16x16x32_bf16 v[184:187], v[72:75], a[232:235], v[184:187]
    buffer_store_dwordx4 v[34:37], v2, s[32:35], s37 offen offset:0 sc1
    v_mfma_f32_16x16x32_bf16 v[212:215], v[72:75], a[236:239], v[212:215]
    ds_read_b128 v[104:107], v10 offset:51200
    v_mfma_f32_16x16x32_bf16 v[132:135], v[76:79], a[224:227], v[132:135]
    v_mfma_f32_16x16x32_bf16 v[160:163], v[76:79], a[228:231], v[160:163]
    ds_read_b128 v[108:111], v10 offset:52224
    v_mfma_f32_16x16x32_bf16 v[188:191], v[76:79], a[232:235], v[188:191]
    v_mfma_f32_16x16x32_bf16 v[216:219], v[76:79], a[236:239], v[216:219]
    ds_read_b128 v[112:115], v10 offset:53248
    v_mfma_f32_16x16x32_bf16 v[136:139], v[80:83], a[224:227], v[136:139]
    v_mfma_f32_16x16x32_bf16 v[164:167], v[80:83], a[228:231], v[164:167]
    ds_read_b128 v[116:119], v10 offset:54272
    v_mfma_f32_16x16x32_bf16 v[192:195], v[80:83], a[232:235], v[192:195]
    v_mfma_f32_16x16x32_bf16 v[220:223], v[80:83], a[236:239], v[220:223]
    ds_read_b128 v[120:123], v10 offset:55296
    v_mfma_f32_16x16x32_bf16 v[140:143], v[84:87], a[224:227], v[140:143]
    v_mfma_f32_16x16x32_bf16 v[168:171], v[84:87], a[228:231], v[168:171]
    ds_read_b128 v[124:127], v11 offset:50176
    v_mfma_f32_16x16x32_bf16 v[196:199], v[84:87], a[232:235], v[196:199]
    v_mfma_f32_16x16x32_bf16 v[224:227], v[84:87], a[236:239], v[224:227]
    ds_read_b128 a[20:23], v9 offset:18432
    v_mfma_f32_16x16x32_bf16 v[144:147], v[88:91], a[224:227], v[144:147]
    v_mfma_f32_16x16x32_bf16 v[172:175], v[88:91], a[228:231], v[172:175]
    ds_read_b128 a[24:27], v9 offset:20480
    v_mfma_f32_16x16x32_bf16 v[200:203], v[88:91], a[232:235], v[200:203]
    s_waitcnt lgkmcnt(6)
    v_max3_u32 v33, v100, v104, v108
    v_mfma_f32_16x16x32_bf16 v[228:231], v[88:91], a[236:239], v[228:231]
    ds_read_b128 a[28:31], v9 offset:22528
    s_waitcnt lgkmcnt(5)
    v_max3_u32 v33, v112, v116, v33
    v_mfma_f32_16x16x32_bf16 v[148:151], v[92:95], a[224:227], v[148:151]
    s_waitcnt lgkmcnt(3)
    v_max3_u32 v33, v120, v124, v33
    v_mfma_f32_16x16x32_bf16 v[176:179], v[92:95], a[228:231], v[176:179]
    v_cmp_eq_u32 s[96:97], -1, v33
    v_mfma_f32_16x16x32_bf16 v[204:207], v[92:95], a[232:235], v[204:207]
    s_cmp_lg_u64 s[96:97], 0
    s_cbranch_scc1 REC15
BK15:
    v_mfma_f32_16x16x32_bf16 v[232:235], v[92:95], a[236:239], v[232:235]
    v_mfma_f32_16x16x32_bf16 v[152:155], v[96:99], a[224:227], v[152:155]
    v_mfma_f32_16x16x32_bf16 v[180:183], v[96:99], a[228:231], v[180:183]
    s_waitcnt vmcnt(1)
    v_cmp_ne_u64 vcc, s[56:57], v[4:5]
    s_cmp_eq_u64 vcc, 0
    s_cbranch_scc0 ol_7
pd_6:
    v_mfma_f32_16x16x32_bf16 v[208:211], v[96:99], a[232:235], v[208:211]
    s_add_u32 s20, s2, 0
    v_mfma_f32_16x16x32_bf16 v[236:239], v[96:99], a[236:239], v[236:239]
    buffer_load_dwordx4 a[32:35], v2, s[32:35], s20 offen offset:0 sc1
    v_mfma_f32_16x16x32_bf16 v[128:131], v[100:103], a[240:243], v[128:131]
    v_add_u32 v4, s7, v2
    v_mfma_f32_16x16x32_bf16 v[156:159], v[100:103], a[244:247], v[156:159]
    s_barrier
    v_mfma_f32_16x16x32_bf16 v[184:187], v[100:103], a[248:251], v[184:187]
    ds_read_b128 v[72:75], v10 offset:0
    v_add_u32 v5, s8, v2
    v_mfma_f32_16x16x32_bf16 v[212:215], v[100:103], a[252:255], v[212:215]
    buffer_load_dwordx4 a[36:39], v2, s[32:35], s20 offen offset:1024 sc1
    v_subrev_u32 v6, 0x200, v5
    v_mfma_f32_16x16x32_bf16 v[132:135], v[104:107], a[240:243], v[132:135]
    ds_read_b128 v[76:79], v10 offset:1024
    v_cndmask_b32 v6, v4, v6, s[14:15]
    v_mfma_f32_16x16x32_bf16 v[160:163], v[104:107], a[244:247], v[160:163]
    v_add_u32 v7, 0x1000, v2
    v_mfma_f32_16x16x32_bf16 v[188:191], v[104:107], a[248:251], v[188:191]
    ds_read_b128 v[80:83], v10 offset:2048
    v_mfma_f32_16x16x32_bf16 v[216:219], v[104:107], a[252:255], v[216:219]
    buffer_load_dwordx4 a[40:43], v2, s[32:35], s20 offen offset:2048 sc1
    v_mfma_f32_16x16x32_bf16 v[136:139], v[108:111], a[240:243], v[136:139]
    ds_read_b128 v[84:87], v10 offset:3072
    v_mfma_f32_16x16x32_bf16 v[164:167], v[108:111], a[244:247], v[164:167]
    v_mfma_f32_16x16x32_bf16 v[192:195], v[108:111], a[248:251], v[192:195]
    ds_read_b128 v[88:91], v10 offset:4096
    v_mfma_f32_16x16x32_bf16 v[220:223], v[108:111], a[252:255], v[220:223]
    buffer_load_dwordx4 a[44:47], v2, s[32:35], s20 offen offset:3072 sc1
    v_mfma_f32_16x16x32_bf16 v[140:143], v[112:115], a[240:243], v[140:143]
    ds_read_b128 v[92:95], v10 offset:5120
    s_add_u32 s20, s2, 4096
    v_mfma_f32_16x16x32_bf16 v[168:171], v[112:115], a[244:247], v[168:171]
    v_mfma_f32_16x16x32_bf16 v[196:199], v[112:115], a[248:251], v[196:199]
    ds_read_b128 v[96:99], v11 offset:0
    v_mfma_f32_16x16x32_bf16 v[224:227], v[112:115], a[252:255], v[224:227]
    buffer_load_dwordx4 a[48:51], v2, s[32:35], s20 offen offset:0 sc1
    v_mfma_f32_16x16x32_bf16 v[144:147], v[116:119], a[240:243], v[144:147]
    v_mfma_f32_16x16x32_bf16 v[172:175], v[116:119], a[244:247], v[172:175]
    v_mfma_f32_16x16x32_bf16 v[200:203], v[116:119], a[248:251], v[200:203]
    v_mfma_f32_16x16x32_bf16 v[228:231], v[116:119], a[252:255], v[228:231]
    buffer_load_dwordx4 a[52:55], v2, s[32:35], s20 offen offset:1024 sc1
    s_waitcnt lgkmcnt(4)
    v_max3_u32 v33, v72, v76, v80
    v_mfma_f32_16x16x32_bf16 v[148:151], v[120:123], a[240:243], v[148:151]
    s_waitcnt lgkmcnt(2)
    v_max3_u32 v33, v84, v88, v33
    v_mfma_f32_16x16x32_bf16 v[176:179], v[120:123], a[244:247], v[176:179]
    s_waitcnt lgkmcnt(0)
    v_max3_u32 v33, v92, v96, v33
    v_mfma_f32_16x16x32_bf16 v[204:207], v[120:123], a[248:251], v[204:207]
    v_cmp_eq_u32 s[96:97], -1, v33
    v_mfma_f32_16x16x32_bf16 v[232:235], v[120:123], a[252:255], v[232:235]
    buffer_load_dwordx4 a[56:59], v2, s[32:35], s20 offen offset:2048 sc1
    v_mfma_f32_16x16x32_bf16 v[152:155], v[124:127], a[240:243], v[152:155]
    s_cmp_lg_u64 s[96:97], 0
    s_cbranch_scc1 REC16
BK16:
    v_mfma_f32_16x16x32_bf16 v[180:183], v[124:127], a[244:247], v[180:183]
    v_mfma_f32_16x16x32_bf16 v[208:211], v[124:127], a[248:251], v[208:211]
    v_mfma_f32_16x16x32_bf16 v[236:239], v[124:127], a[252:255], v[236:239]
    buffer_load_dwordx4 a[60:63], v2, s[32:35], s20 offen offset:3072 sc1
    v_mfma_f32_16x16x32_bf16 v[128:131], v[72:75], a[0:3], v[128:131]
    s_add_u32 s20, s2, 8192
    v_mfma_f32_16x16x32_bf16 v[156:159], v[72:75], a[4:7], v[156:159]
    ds_read_b128 v[100:103], v10 offset:7168
    v_mfma_f32_16x16x32_bf16 v[184:187], v[72:75], a[8:11], v[184:187]
    s_mov_b32 exec_hi, 0
    v_mov_b32 v31, v30
    ds_write_b64 v12, v[30:31] offset:20552
    ds_write_b64 v13, v[30:31] offset:20552
    ds_write_b64 v16, v[30:31] offset:5160
    ds_write_b64 v16, v[30:31] offset:6696
    v_mov_b32 v31, 0
    s_mov_b32 exec_hi, -1
    v_mfma_f32_16x16x32_bf16 v[212:215], v[72:75], a[12:15], v[212:215]
    buffer_load_dwordx4 a[64:67], v2, s[32:35], s20 offen offset:0 sc1
    ds_read_b128 v[104:107], v10 offset:8192
    v_mfma_f32_16x16x32_bf16 v[132:135], v[76:79], a[0:3], v[132:135]
    v_mfma_f32_16x16x32_bf16 v[160:163], v[76:79], a[4:7], v[160:163]
    ds_read_b128 v[108:111], v10 offset:9216
    v_mfma_f32_16x16x32_bf16 v[188:191], v[76:79], a[8:11], v[188:191]
    v_mfma_f32_16x16x32_bf16 v[216:219], v[76:79], a[12:15], v[216:219]
    buffer_load_dwordx4 a[68:71], v2, s[32:35], s20 offen offset:1024 sc1
    ds_read_b128 v[112:115], v10 offset:10240
    v_mfma_f32_16x16x32_bf16 v[136:139], v[80:83], a[0:3], v[136:139]
    v_mfma_f32_16x16x32_bf16 v[164:167], v[80:83], a[4:7], v[164:167]
    ds_read_b128 v[116:119], v10 offset:11264
    v_mfma_f32_16x16x32_bf16 v[192:195], v[80:83], a[8:11], v[192:195]
    v_mfma_f32_16x16x32_bf16 v[220:223], v[80:83], a[12:15], v[220:223]
    buffer_load_dwordx4 a[72:75], v2, s[32:35], s20 offen offset:2048 sc1
    ds_read_b128 v[120:123], v10 offset:12288
    v_mfma_f32_16x16x32_bf16 v[140:143], v[84:87], a[0:3], v[140:143]
    v_mfma_f32_16x16x32_bf16 v[168:171], v[84:87], a[4:7], v[168:171]
    ds_read_b128 v[124:127], v11 offset:7168
    v_mfma_f32_16x16x32_bf16 v[196:199], v[84:87], a[8:11], v[196:199]
    v_mfma_f32_16x16x32_bf16 v[224:227], v[84:87], a[12:15], v[224:227]
    buffer_load_dwordx4 a[76:79], v2, s[32:35], s20 offen offset:3072 sc1
    v_mfma_f32_16x16x32_bf16 v[144:147], v[88:91], a[0:3], v[144:147]
    v_and_b32 v22, 15, v1
    v_lshlrev_b32 v22, 3, v22
    v_mfma_f32_16x16x32_bf16 v[172:175], v[88:91], a[4:7], v[172:175]
    v_sub_u32 v8, v0, v22
    v_sub_u32 v9, v7, v22
    v_mfma_f32_16x16x32_bf16 v[200:203], v[88:91], a[8:11], v[200:203]
    s_waitcnt lgkmcnt(4)
    v_max3_u32 v33, v100, v104, v108
    v_cndmask_b32 v22, 0, 1, s[14:15]
    v_mfma_f32_16x16x32_bf16 v[228:231], v[88:91], a[12:15], v[228:231]
    s_waitcnt lgkmcnt(2)
    v_max3_u32 v33, v112, v116, v33
    v_mul_u32_u24 v22, 4864, v22
    v_mfma_f32_16x16x32_bf16 v[148:151], v[92:95], a[0:3], v[148:151]
    s_waitcnt lgkmcnt(0)
    v_max3_u32 v33, v120, v124, v33
    v_add_u32 v26, v8, v22
    v_mfma_f32_16x16x32_bf16 v[176:179], v[92:95], a[4:7], v[176:179]
    buffer_store_dwordx2 v[34:35], v26, s[32:35], s11 offen sc1
    v_cmp_eq_u32 s[96:97], -1, v33
    v_mfma_f32_16x16x32_bf16 v[204:207], v[92:95], a[8:11], v[204:207]
    s_cmp_lg_u64 s[96:97], 0
    s_cbranch_scc1 REC17
BK17:
    v_mfma_f32_16x16x32_bf16 v[232:235], v[92:95], a[12:15], v[232:235]
    s_add_u32 s20, s2, 12288
    v_mfma_f32_16x16x32_bf16 v[152:155], v[96:99], a[0:3], v[152:155]
    v_mfma_f32_16x16x32_bf16 v[180:183], v[96:99], a[4:7], v[180:183]
    buffer_load_dwordx4 a[80:83], v2, s[32:35], s20 offen offset:0 sc1
    v_mfma_f32_16x16x32_bf16 v[208:211], v[96:99], a[8:11], v[208:211]
    v_mfma_f32_16x16x32_bf16 v[236:239], v[96:99], a[12:15], v[236:239]
    v_mfma_f32_16x16x32_bf16 v[128:131], v[100:103], a[16:19], v[128:131]
    v_mfma_f32_16x16x32_bf16 v[156:159], v[100:103], a[20:23], v[156:159]
    buffer_load_dwordx4 a[84:87], v2, s[32:35], s20 offen offset:1024 sc1
    v_mfma_f32_16x16x32_bf16 v[184:187], v[100:103], a[24:27], v[184:187]
    v_mfma_f32_16x16x32_bf16 v[212:215], v[100:103], a[28:31], v[212:215]
    v_mfma_f32_16x16x32_bf16 v[132:135], v[104:107], a[16:19], v[132:135]
    v_mfma_f32_16x16x32_bf16 v[160:163], v[104:107], a[20:23], v[160:163]
    buffer_load_dwordx4 a[88:91], v2, s[32:35], s20 offen offset:2048 sc1
    v_mfma_f32_16x16x32_bf16 v[188:191], v[104:107], a[24:27], v[188:191]
    v_mfma_f32_16x16x32_bf16 v[216:219], v[104:107], a[28:31], v[216:219]
    v_mfma_f32_16x16x32_bf16 v[136:139], v[108:111], a[16:19], v[136:139]
    v_mfma_f32_16x16x32_bf16 v[164:167], v[108:111], a[20:23], v[164:167]
    buffer_load_dwordx4 a[92:95], v2, s[32:35], s20 offen offset:3072 sc1
    v_mfma_f32_16x16x32_bf16 v[192:195], v[108:111], a[24:27], v[192:195]
    s_add_u32 s20, s2, 16384
    v_mfma_f32_16x16x32_bf16 v[220:223], v[108:111], a[28:31], v[220:223]
    v_mfma_f32_16x16x32_bf16 v[140:143], v[112:115], a[16:19], v[140:143]
    v_mfma_f32_16x16x32_bf16 v[168:171], v[112:115], a[20:23], v[168:171]
    buffer_load_dwordx4 a[96:99], v2, s[32:35], s20 offen offset:0 sc1
    v_mfma_f32_16x16x32_bf16 v[196:199], v[112:115], a[24:27], v[196:199]
    v_mfma_f32_16x16x32_bf16 v[224:227], v[112:115], a[28:31], v[224:227]
    v_mfma_f32_16x16x32_bf16 v[144:147], v[116:119], a[16:19], v[144:147]
    v_mfma_f32_16x16x32_bf16 v[172:175], v[116:119], a[20:23], v[172:175]
    buffer_load_dwordx4 a[100:103], v2, s[32:35], s20 offen offset:1024 sc1
    v_mfma_f32_16x16x32_bf16 v[200:203], v[116:119], a[24:27], v[200:203]
    v_mfma_f32_16x16x32_bf16 v[228:231], v[116:119], a[28:31], v[228:231]
    v_mfma_f32_16x16x32_bf16 v[148:151], v[120:123], a[16:19], v[148:151]
    v_mfma_f32_16x16x32_bf16 v[176:179], v[120:123], a[20:23], v[176:179]
    buffer_load_dwordx4 a[104:107], v2, s[32:35], s20 offen offset:2048 sc1
    v_mfma_f32_16x16x32_bf16 v[204:207], v[120:123], a[24:27], v[204:207]
    v_mfma_f32_16x16x32_bf16 v[232:235], v[120:123], a[28:31], v[232:235]
    v_mfma_f32_16x16x32_bf16 v[152:155], v[124:127], a[16:19], v[152:155]
    v_mfma_f32_16x16x32_bf16 v[180:183], v[124:127], a[20:23], v[180:183]
    buffer_load_dwordx4 a[108:111], v2, s[32:35], s20 offen offset:3072 sc1
    v_mfma_f32_16x16x32_bf16 v[208:211], v[124:127], a[24:27], v[208:211]
    s_add_u32 s20, s2, 20480
    v_mfma_f32_16x16x32_bf16 v[236:239], v[124:127], a[28:31], v[236:239]
    buffer_load_dwordx4 a[112:115], v2, s[32:35], s20 offen offset:0 sc1
    buffer_load_dwordx4 a[116:119], v2, s[32:35], s20 offen offset:1024 sc1
    buffer_load_dwordx4 a[120:123], v2, s[32:35], s20 offen offset:2048 sc1
    buffer_load_dwordx4 a[124:127], v2, s[32:35], s20 offen offset:3072 sc1
    v_mov_b32 v10, s56
    v_mov_b32 v11, s57
    v_mov_b32 v33, 0
    v_mov_b32 v35, 0
    v_mov_b32 v36, 0
    v_mov_b32 v37, 0
    v_cvt_pk_bf16_f32 v128, v128, v129
    v_cvt_pk_bf16_f32 v129, v130, v131
    v_cvt_pk_bf16_f32 v130, v156, v157
    v_cvt_pk_bf16_f32 v131, v158, v159
    v_cvt_pk_bf16_f32 v184, v184, v185
    v_cvt_pk_bf16_f32 v185, v186, v187
    v_cvt_pk_bf16_f32 v186, v212, v213
    v_cvt_pk_bf16_f32 v187, v214, v215
    v_permlane16_swap_b32 v128, v130
    v_permlane16_swap_b32 v129, v131
    v_permlane16_swap_b32 v184, v186
    v_permlane16_swap_b32 v185, v187
    ds_write_b128 v12, v[128:131] offset:20480
    ds_write_b128 v13, v[184:187] offset:20480
    v_cvt_pk_bf16_f32 v132, v132, v133
    v_cvt_pk_bf16_f32 v133, v134, v135
    v_cvt_pk_bf16_f32 v134, v160, v161
    v_cvt_pk_bf16_f32 v135, v162, v163
    v_cvt_pk_bf16_f32 v188, v188, v189
    v_cvt_pk_bf16_f32 v189, v190, v191
    v_cvt_pk_bf16_f32 v190, v216, v217
    v_cvt_pk_bf16_f32 v191, v218, v219
    v_permlane16_swap_b32 v132, v134
    v_permlane16_swap_b32 v133, v135
    v_permlane16_swap_b32 v188, v190
    v_permlane16_swap_b32 v189, v191
    ds_write_b128 v12, v[132:135] offset:20512
    ds_write_b128 v13, v[188:191] offset:20512
    s_mov_b32 exec_lo, 0
    s_mov_b32 exec_hi, 0xffff
    v_mul_f32 v152, s24, v152
    v_mul_f32 v153, s24, v153
    v_mul_f32 v180, s24, v180
    v_mul_f32 v181, s24, v181
    v_mul_f32 v208, s24, v208
    v_mul_f32 v209, s24, v209
    v_mul_f32 v236, s24, v236
    v_mul_f32 v237, s24, v237
    s_mov_b64 exec, -1
    v_mov_b32 v96, v155
    v_mov_b32 v97, v211
    v_cvt_pk_bf16_f32 v152, v152, v153
    v_cvt_pk_bf16_f32 v153, v154, v155
    v_cvt_pk_bf16_f32 v154, v180, v181
    v_cvt_pk_bf16_f32 v155, v182, v183
    v_cvt_pk_bf16_f32 v208, v208, v209
    v_cvt_pk_bf16_f32 v209, v210, v211
    v_cvt_pk_bf16_f32 v210, v236, v237
    v_cvt_pk_bf16_f32 v211, v238, v239
    v_permlane16_swap_b32 v152, v154
    v_permlane16_swap_b32 v153, v155
    v_permlane16_swap_b32 v208, v210
    v_permlane16_swap_b32 v209, v211
    s_mov_b32 exec_hi, 0
    ds_write_b64 v12, v[152:153] offset:20544
    ds_write_b64 v13, v[208:209] offset:20544
    ds_write_b64 v16, v[154:155] offset:5152
    ds_write_b64 v16, v[210:211] offset:6688
    s_mov_b32 exec_hi, -1
    ds_read_b128 v[100:103], v4 offset:20480
    ds_read_b128 v[104:107], v4 offset:21504
    ds_read_b128 v[108:111], v5 offset:20480
    ds_read_b128 v[112:115], v5 offset:21504
    ds_read_b128 v[116:119], v6 offset:22528
    v_cvt_pk_bf16_f32 v136, v136, v137
    v_cvt_pk_bf16_f32 v137, v138, v139
    v_cvt_pk_bf16_f32 v138, v164, v165
    v_cvt_pk_bf16_f32 v139, v166, v167
    v_cvt_pk_bf16_f32 v192, v192, v193
    v_cvt_pk_bf16_f32 v193, v194, v195
    v_cvt_pk_bf16_f32 v194, v220, v221
    v_cvt_pk_bf16_f32 v195, v222, v223
    v_permlane16_swap_b32 v136, v138
    v_permlane16_swap_b32 v137, v139
    v_permlane16_swap_b32 v192, v194
    v_permlane16_swap_b32 v193, v195
    v_cndmask_b32 v22, v154, 0, s[14:15]
    v_cndmask_b32 v26, v210, 0, s[14:15]
    s_waitcnt lgkmcnt(4)
    buffer_store_dwordx4 v[100:103], v4, s[32:35], s25 offen offset:0 sc1
    s_waitcnt lgkmcnt(3)
    buffer_store_dwordx4 v[104:107], v4, s[32:35], s25 offen offset:1024 sc1
    s_waitcnt lgkmcnt(2)
    buffer_store_dwordx4 v[108:111], v5, s[32:35], s25 offen offset:0 sc1
    s_waitcnt lgkmcnt(1)
    buffer_store_dwordx4 v[112:115], v5, s[32:35], s25 offen offset:1024 sc1
    s_waitcnt lgkmcnt(0)
    buffer_store_dwordx4 v[116:119], v6, s[32:35], s25 offen offset:2048 sc1
    v_cvt_pk_bf16_f32 v140, v140, v141
    v_cvt_pk_bf16_f32 v141, v142, v143
    v_cvt_pk_bf16_f32 v142, v168, v169
    v_cvt_pk_bf16_f32 v143, v170, v171
    v_cvt_pk_bf16_f32 v196, v196, v197
    v_cvt_pk_bf16_f32 v197, v198, v199
    v_cvt_pk_bf16_f32 v198, v224, v225
    v_cvt_pk_bf16_f32 v199, v226, v227
    v_permlane16_swap_b32 v140, v142
    v_permlane16_swap_b32 v141, v143
    v_permlane16_swap_b32 v196, v198
    v_permlane16_swap_b32 v197, v199
    ds_write_b128 v16, v[140:143] offset:5120
    ds_write_b128 v16, v[196:199] offset:6656
    v_mul_f32 v144, s24, v144
    v_mul_f32 v145, s24, v145
    v_mul_f32 v146, s24, v146
    v_mul_f32 v147, s24, v147
    v_mul_f32 v172, s24, v172
    v_mul_f32 v173, s24, v173
    v_mul_f32 v174, s24, v174
    v_mul_f32 v175, s24, v175
    v_mul_f32 v200, s24, v200
    v_mul_f32 v201, s24, v201
    v_mul_f32 v202, s24, v202
    v_mul_f32 v203, s24, v203
    v_mul_f32 v228, s24, v228
    v_mul_f32 v229, s24, v229
    v_mul_f32 v230, s24, v230
    v_mul_f32 v231, s24, v231
    v_cvt_pk_bf16_f32 v72, v144, v145
    v_cvt_pk_bf16_f32 v73, v146, v147
    v_cvt_pk_bf16_f32 v74, v172, v173
    v_cvt_pk_bf16_f32 v75, v174, v175
    v_cvt_pk_bf16_f32 v76, v200, v201
    v_cvt_pk_bf16_f32 v77, v202, v203
    v_cvt_pk_bf16_f32 v78, v228, v229
    v_cvt_pk_bf16_f32 v79, v230, v231
    v_permlane16_swap_b32 v72, v74
    v_permlane16_swap_b32 v73, v75
    v_permlane16_swap_b32 v76, v78
    v_permlane16_swap_b32 v77, v79
    v_cvt_pk_bf16_f32 v148, v148, v149
    v_cvt_pk_bf16_f32 v149, v150, v151
    v_cvt_pk_bf16_f32 v150, v176, v177
    v_cvt_pk_bf16_f32 v151, v178, v179
    v_cvt_pk_bf16_f32 v204, v204, v205
    v_cvt_pk_bf16_f32 v205, v206, v207
    v_cvt_pk_bf16_f32 v206, v232, v233
    v_cvt_pk_bf16_f32 v207, v234, v235
    v_permlane16_swap_b32 v148, v150
    v_permlane16_swap_b32 v149, v151
    v_permlane16_swap_b32 v204, v206
    v_permlane16_swap_b32 v205, v207
    v_cndmask_b32 v30, 0, v152, s[14:15]
    v_permlane16_swap_b32 v96, v183
    v_cndmask_b32 v34, 0, v208, s[14:15]
    v_permlane16_swap_b32 v97, v239
    v_mov_b32 v96, v183
    v_mov_b32 v97, v239
    s_nop 0
    v_permlane32_swap_b32 v183, v96
    v_permlane32_swap_b32 v239, v97
    v_mfma_f32_32x32x16_bf16 v[156:171], v[240:243], v[136:139], 0
    v_mul_f32 v96, s22, v96
    v_mfma_f32_32x32x16_bf16 v[100:115], v[248:251], v[136:139], 0
    v_mul_f32 v97, s22, v97
    v_mfma_f32_32x32x16_bf16 v[156:171], v[244:247], v[22:25], v[156:171]
    v_exp_f32 v96, -v96
    v_mfma_f32_32x32x16_bf16 v[100:115], v[252:255], v[22:25], v[100:115]
    v_exp_f32 v97, -v97
    v_add_f32 v96, 1.0, v96
    v_add_f32 v97, 1.0, v97
    v_rcp_f32 v96, v96
    v_rcp_f32 v97, v97
    v_mfma_f32_32x32x16_bf16 v[212:227], v[240:243], v[192:195], 0
    s_nop 3
    v_mfma_f32_32x32x16_bf16 v[102:117], v[248:251], v[192:195], 0
    v_mfma_f32_32x32x16_bf16 v[212:227], v[244:247], v[26:29], v[212:227]
    v_mfma_f32_32x32x16_bf16 v[102:117], v[252:255], v[26:29], v[102:117]
    v_max3_f32 v232, v156, v157, v158
    v_max3_f32 v233, v159, v160, v161
    v_max3_f32 v232, v162, v163, v232
    v_max3_f32 v233, v164, v165, v233
    v_max3_f32 v232, v166, v167, v232
    v_max3_f32 v233, v168, v169, v233
    v_max3_f32 v232, v170, v171, v232
    v_max3_f32 v233, v100, v101, v233
    v_cndmask_b32 v22, 0, v153, s[14:15]
    v_max_f32 v232, v232, v233
    v_mul_f32 v232, s22, v232
    v_fma_f32 v156, v156, s22, -v232
    v_fma_f32 v157, v157, s22, -v232
    v_fma_f32 v158, v158, s22, -v232
    v_fma_f32 v159, v159, s22, -v232
    v_exp_f32 v156, v156
    v_exp_f32 v157, v157
    v_mfma_f32_32x32x16_bf16 v[172:187], v[240:243], v[148:151], 0
    v_fma_f32 v160, v160, s22, -v232
    v_fma_f32 v161, v161, s22, -v232
    v_exp_f32 v158, v158
    v_exp_f32 v159, v159
    v_fma_f32 v162, v162, s22, -v232
    v_fma_f32 v163, v163, s22, -v232
    v_exp_f32 v160, v160
    v_exp_f32 v161, v161
    v_mfma_f32_32x32x16_bf16 v[104:119], v[248:251], v[148:151], 0
    v_add_f32 v234, v156, v158
    v_add_f32 v235, v157, v159
    v_fma_f32 v164, v164, s22, -v232
    v_fma_f32 v165, v165, s22, -v232
    v_exp_f32 v162, v162
    v_exp_f32 v163, v163
    v_add_f32 v234, v234, v160
    v_add_f32 v235, v235, v161
    v_mfma_f32_32x32x16_bf16 v[172:187], v[244:247], v[22:25], v[172:187]
    v_fma_f32 v166, v166, s22, -v232
    v_fma_f32 v167, v167, s22, -v232
    v_exp_f32 v164, v164
    v_exp_f32 v165, v165
    v_add_f32 v234, v234, v162
    v_add_f32 v235, v235, v163
    v_fma_f32 v168, v168, s22, -v232
    v_fma_f32 v169, v169, s22, -v232
    v_mfma_f32_32x32x16_bf16 v[104:119], v[252:255], v[22:25], v[104:119]
    v_exp_f32 v166, v166
    v_exp_f32 v167, v167
    v_add_f32 v234, v234, v164
    v_add_f32 v235, v235, v165
    v_fma_f32 v170, v170, s22, -v232
    v_fma_f32 v171, v171, s22, -v232
    v_exp_f32 v168, v168
    v_exp_f32 v169, v169
    s_add_u32 s20, s2, 24576
    buffer_load_dwordx4 a[128:131], v2, s[32:35], s20 offen offset:0 sc1
    v_add_f32 v234, v234, v166
    v_add_f32 v235, v235, v167
    v_fma_f32 v100, v100, s22, -v232
    v_fma_f32 v101, v101, s22, -v232
    v_exp_f32 v170, v170
    v_exp_f32 v171, v171
    v_add_f32 v234, v234, v168
    v_add_f32 v235, v235, v169
    buffer_load_dwordx4 a[132:135], v2, s[32:35], s20 offen offset:1024 sc1
    v_exp_f32 v100, v100
    v_exp_f32 v101, v101
    v_add_f32 v234, v234, v170
    v_add_f32 v235, v235, v171
    v_add_f32 v234, v234, v235
    v_add_f32 v235, v100, v101
    v_add_f32 v234, v234, v235
    v_rcp_f32 v232, v234
    buffer_load_dwordx4 a[136:139], v2, s[32:35], s20 offen offset:2048 sc1
    v_mul_f32 v156, v156, v232
    v_mul_f32 v157, v157, v232
    v_cvt_pk_bf16_f32 v156, v156, v157
    v_mul_f32 v158, v158, v232
    v_mul_f32 v159, v159, v232
    v_cvt_pk_bf16_f32 v157, v158, v159
    v_mul_f32 v160, v160, v232
    v_mul_f32 v161, v161, v232
    buffer_load_dwordx4 a[140:143], v2, s[32:35], s20 offen offset:3072 sc1
    v_cvt_pk_bf16_f32 v158, v160, v161
    v_mul_f32 v162, v162, v232
    v_mul_f32 v163, v163, v232
    v_cvt_pk_bf16_f32 v159, v162, v163
    v_mul_f32 v164, v164, v232
    v_mul_f32 v165, v165, v232
    v_cvt_pk_bf16_f32 v160, v164, v165
    v_mul_f32 v166, v166, v232
    v_mul_f32 v167, v167, v232
    v_cvt_pk_bf16_f32 v161, v166, v167
    v_mul_f32 v168, v168, v232
    v_mul_f32 v169, v169, v232
    v_cvt_pk_bf16_f32 v162, v168, v169
    v_mul_f32 v170, v170, v232
    v_mul_f32 v171, v171, v232
    v_cvt_pk_bf16_f32 v163, v170, v171
    v_mul_f32 v100, v100, v232
    v_mul_f32 v101, v101, v232
    v_cvt_pk_bf16_f32 v100, v100, v101
    ds_write_b128 v17, v[156:159] offset:0
    ds_write_b128 v17, v[160:163] offset:16
    ds_write_b32 v18, v100 offset:64
    v_max3_f32 v232, v212, v213, v214
    v_max3_f32 v233, v215, v216, v217
    v_max3_f32 v232, v218, v219, v232
    v_max3_f32 v233, v220, v221, v233
    v_max3_f32 v232, v222, v223, v232
    v_max3_f32 v233, v224, v225, v233
    v_max3_f32 v232, v226, v227, v232
    v_max3_f32 v233, v102, v103, v233
    v_cndmask_b32 v26, 0, v209, s[14:15]
    v_max_f32 v232, v232, v233
    v_mul_f32 v232, s22, v232
    v_fma_f32 v212, v212, s22, -v232
    v_fma_f32 v213, v213, s22, -v232
    v_fma_f32 v214, v214, s22, -v232
    v_fma_f32 v215, v215, s22, -v232
    v_exp_f32 v212, v212
    v_exp_f32 v213, v213
    v_mfma_f32_32x32x16_bf16 v[128:143], v[240:243], v[204:207], 0
    v_fma_f32 v216, v216, s22, -v232
    v_fma_f32 v217, v217, s22, -v232
    v_exp_f32 v214, v214
    v_exp_f32 v215, v215
    v_fma_f32 v218, v218, s22, -v232
    v_fma_f32 v219, v219, s22, -v232
    v_exp_f32 v216, v216
    v_exp_f32 v217, v217
    v_mfma_f32_32x32x16_bf16 v[106:121], v[248:251], v[204:207], 0
    v_add_f32 v234, v212, v214
    v_add_f32 v235, v213, v215
    v_fma_f32 v220, v220, s22, -v232
    v_fma_f32 v221, v221, s22, -v232
    v_exp_f32 v218, v218
    v_exp_f32 v219, v219
    v_add_f32 v234, v234, v216
    v_add_f32 v235, v235, v217
    v_mfma_f32_32x32x16_bf16 v[128:143], v[244:247], v[26:29], v[128:143]
    v_fma_f32 v222, v222, s22, -v232
    v_fma_f32 v223, v223, s22, -v232
    v_exp_f32 v220, v220
    v_exp_f32 v221, v221
    v_add_f32 v234, v234, v218
    v_add_f32 v235, v235, v219
    v_fma_f32 v224, v224, s22, -v232
    v_fma_f32 v225, v225, s22, -v232
    v_mfma_f32_32x32x16_bf16 v[106:121], v[252:255], v[26:29], v[106:121]
    v_exp_f32 v222, v222
    v_exp_f32 v223, v223
    v_add_f32 v234, v234, v220
    v_add_f32 v235, v235, v221
    v_fma_f32 v226, v226, s22, -v232
    v_fma_f32 v227, v227, s22, -v232
    v_exp_f32 v224, v224
    v_exp_f32 v225, v225
    s_add_u32 s20, s2, 28672
    buffer_load_dwordx4 a[144:147], v2, s[32:35], s20 offen offset:0 sc1
    v_add_f32 v234, v234, v222
    v_add_f32 v235, v235, v223
    v_fma_f32 v102, v102, s22, -v232
    v_fma_f32 v103, v103, s22, -v232
    v_exp_f32 v226, v226
    v_exp_f32 v227, v227
    v_add_f32 v234, v234, v224
    v_add_f32 v235, v235, v225
    buffer_load_dwordx4 a[148:151], v2, s[32:35], s20 offen offset:1024 sc1
    v_exp_f32 v102, v102
    v_exp_f32 v103, v103
    v_add_f32 v234, v234, v226
    v_add_f32 v235, v235, v227
    v_add_f32 v234, v234, v235
    v_add_f32 v235, v102, v103
    v_add_f32 v234, v234, v235
    v_rcp_f32 v232, v234
    buffer_load_dwordx4 a[152:155], v2, s[32:35], s20 offen offset:2048 sc1
    v_mul_f32 v212, v212, v232
    v_mul_f32 v213, v213, v232
    v_cvt_pk_bf16_f32 v212, v212, v213
    v_mul_f32 v214, v214, v232
    v_mul_f32 v215, v215, v232
    v_cvt_pk_bf16_f32 v213, v214, v215
    v_mul_f32 v216, v216, v232
    v_mul_f32 v217, v217, v232
    buffer_load_dwordx4 a[156:159], v2, s[32:35], s20 offen offset:3072 sc1
    v_cvt_pk_bf16_f32 v214, v216, v217
    v_mul_f32 v218, v218, v232
    v_mul_f32 v219, v219, v232
    v_cvt_pk_bf16_f32 v215, v218, v219
    v_mul_f32 v220, v220, v232
    v_mul_f32 v221, v221, v232
    v_cvt_pk_bf16_f32 v216, v220, v221
    v_mul_f32 v222, v222, v232
    v_mul_f32 v223, v223, v232
    v_cvt_pk_bf16_f32 v217, v222, v223
    v_mul_f32 v224, v224, v232
    v_mul_f32 v225, v225, v232
    v_cvt_pk_bf16_f32 v218, v224, v225
    v_mul_f32 v226, v226, v232
    v_mul_f32 v227, v227, v232
    v_cvt_pk_bf16_f32 v219, v226, v227
    v_mul_f32 v102, v102, v232
    v_mul_f32 v103, v103, v232
    v_cvt_pk_bf16_f32 v102, v102, v103
    ds_write_b128 v17, v[212:215] offset:2560
    ds_write_b128 v17, v[216:219] offset:2576
    ds_write_b32 v18, v102 offset:2624
    ds_read_b64_tr_b16 v[212:213], v19 offset:0
    ds_read_b64_tr_b16 v[214:215], v19 offset:320
    ds_read_b64_tr_b16 v[220:221], v21 offset:5120
    ds_read_b64_tr_b16 v[222:223], v21 offset:5312
    ds_read_b64_tr_b16 v[216:217], v20 offset:64
    ds_read_b64_tr_b16 v[218:219], v20 offset:384
    ds_read_b64_tr_b16 v[224:225], v19 offset:1280
    ds_read_b64_tr_b16 v[226:227], v19 offset:1600
    ds_read_b64_tr_b16 v[192:193], v21 offset:5888
    ds_read_b64_tr_b16 v[194:195], v21 offset:6080
    ds_read_b64_tr_b16 v[188:189], v20 offset:1344
    ds_read_b64_tr_b16 v[190:191], v20 offset:1664
    ds_read_b64_tr_b16 v[196:197], v19 offset:2560
    ds_read_b64_tr_b16 v[198:199], v19 offset:2880
    ds_read_b64_tr_b16 v[228:229], v21 offset:6656
    ds_read_b64_tr_b16 v[230:231], v21 offset:6848
    ds_read_b64_tr_b16 v[200:201], v20 offset:2624
    ds_read_b64_tr_b16 v[202:203], v20 offset:2944
    ds_read_b64_tr_b16 v[144:145], v19 offset:3840
    ds_read_b64_tr_b16 v[146:147], v19 offset:4160
    ds_read_b64_tr_b16 v[208:209], v21 offset:7424
    ds_read_b64_tr_b16 v[210:211], v21 offset:7616
    ds_read_b64_tr_b16 v[236:237], v20 offset:3904
    ds_read_b64_tr_b16 v[238:239], v20 offset:4224
    s_waitcnt vmcnt(8)
    s_mov_b64 exec, 1
    buffer_store_dwordx2 v[10:11], off, s[32:35], s27 sc1
    s_mov_b64 exec, -1
    s_mov_b64 exec, 1
    buffer_store_dwordx2 v[10:11], off, s[32:35], s43 sc1
    s_mov_b64 exec, -1
    v_max3_f32 v232, v172, v173, v174
    v_max3_f32 v233, v175, v176, v177
    v_max3_f32 v232, v178, v179, v232
    v_max3_f32 v233, v180, v181, v233
    v_max3_f32 v232, v182, v183, v232
    v_max3_f32 v233, v184, v185, v233
    v_max3_f32 v232, v186, v187, v232
    s_waitcnt lgkmcnt(15)
    v_mfma_f32_32x32x16_bf16 v[156:171], v[212:215], v[220:223], 0
    v_max3_f32 v233, v104, v105, v233
    v_max_f32 v232, v232, v233
    v_mul_f32 v232, s22, v232
    v_fma_f32 v172, v172, s22, -v232
    v_fma_f32 v173, v173, s22, -v232
    v_fma_f32 v174, v174, s22, -v232
    v_fma_f32 v175, v175, s22, -v232
    v_mfma_f32_32x32x16_bf16 v[108:123], v[216:219], v[220:223], 0
    v_exp_f32 v172, v172
    v_exp_f32 v173, v173
    v_fma_f32 v176, v176, s22, -v232
    v_fma_f32 v177, v177, s22, -v232
    v_exp_f32 v174, v174
    v_exp_f32 v175, v175
    v_fma_f32 v178, v178, s22, -v232
    s_waitcnt lgkmcnt(14)
    v_mfma_f32_32x32x16_bf16 v[156:171], v[224:227], v[192:195], v[156:171]
    v_fma_f32 v179, v179, s22, -v232
    v_exp_f32 v176, v176
    v_exp_f32 v177, v177
    v_add_f32 v234, v172, v174
    v_add_f32 v235, v173, v175
    v_fma_f32 v180, v180, s22, -v232
    v_fma_f32 v181, v181, s22, -v232
    s_waitcnt lgkmcnt(12)
    v_mfma_f32_32x32x16_bf16 v[108:123], v[188:191], v[192:195], v[108:123]
    v_exp_f32 v178, v178
    v_exp_f32 v179, v179
    v_add_f32 v234, v234, v176
    v_add_f32 v235, v235, v177
    v_fma_f32 v182, v182, s22, -v232
    v_fma_f32 v183, v183, s22, -v232
    v_exp_f32 v180, v180
    s_waitcnt lgkmcnt(8)
    v_mfma_f32_32x32x16_bf16 v[156:171], v[196:199], v[228:231], v[156:171]
    v_exp_f32 v181, v181
    v_add_f32 v234, v234, v178
    v_add_f32 v235, v235, v179
    v_fma_f32 v184, v184, s22, -v232
    v_fma_f32 v185, v185, s22, -v232
    v_exp_f32 v182, v182
    v_exp_f32 v183, v183
    s_waitcnt lgkmcnt(6)
    v_mfma_f32_32x32x16_bf16 v[108:123], v[200:203], v[228:231], v[108:123]
    v_add_f32 v234, v234, v180
    v_add_f32 v235, v235, v181
    v_fma_f32 v186, v186, s22, -v232
    v_fma_f32 v187, v187, s22, -v232
    v_exp_f32 v184, v184
    v_exp_f32 v185, v185
    v_add_f32 v234, v234, v182
    s_waitcnt lgkmcnt(2)
    v_mfma_f32_32x32x16_bf16 v[156:171], v[144:147], v[208:211], v[156:171]
    v_add_f32 v235, v235, v183
    v_fma_f32 v104, v104, s22, -v232
    v_fma_f32 v105, v105, s22, -v232
    v_exp_f32 v186, v186
    v_exp_f32 v187, v187
    v_add_f32 v234, v234, v184
    v_add_f32 v235, v235, v185
    s_waitcnt lgkmcnt(0)
    v_mfma_f32_32x32x16_bf16 v[108:123], v[236:239], v[208:211], v[108:123]
    v_exp_f32 v104, v104
    v_exp_f32 v105, v105
    v_add_f32 v234, v234, v186
    v_add_f32 v235, v235, v187
    v_add_f32 v234, v234, v235
    v_add_f32 v235, v104, v105
    v_add_f32 v234, v234, v235
    v_rcp_f32 v232, v234
    s_nop 0
    v_mul_f32 v172, v172, v232
    v_mul_f32 v173, v173, v232
    v_cvt_pk_bf16_f32 v80, v172, v173
    v_mul_f32 v174, v174, v232
    v_mul_f32 v175, v175, v232
    v_cvt_pk_bf16_f32 v81, v174, v175
    v_mul_f32 v176, v176, v232
    v_mul_f32 v177, v177, v232
    v_cvt_pk_bf16_f32 v82, v176, v177
    v_mul_f32 v178, v178, v232
    v_mul_f32 v179, v179, v232
    v_cvt_pk_bf16_f32 v83, v178, v179
    v_mul_f32 v180, v180, v232
    v_mul_f32 v181, v181, v232
    v_cvt_pk_bf16_f32 v84, v180, v181
    v_mul_f32 v182, v182, v232
    v_mul_f32 v183, v183, v232
    v_cvt_pk_bf16_f32 v85, v182, v183
    v_mul_f32 v184, v184, v232
    v_mul_f32 v185, v185, v232
    v_cvt_pk_bf16_f32 v86, v184, v185
    v_mul_f32 v186, v186, v232
    v_mul_f32 v187, v187, v232
    v_cvt_pk_bf16_f32 v87, v186, v187
    v_mul_f32 v104, v104, v232
    v_mul_f32 v105, v105, v232
    v_cvt_pk_bf16_f32 v22, v104, v105
    v_add_u32 v17, s4, v2
    v_add_u32 v18, s5, v2
    s_mov_b32 exec_lo, 0xffffff
    s_mov_b32 exec_hi, 0xffffff
    ds_write_b128 v17, v[156:159] offset:0
    ds_write_b128 v17, v[160:163] offset:1024
    ds_write_b128 v17, v[164:167] offset:2048
    ds_write_b128 v17, v[168:171] offset:3072
    ds_write_b64 v3, v[108:109]
    s_mov_b64 exec, -1
    s_waitcnt lgkmcnt(0)
    s_barrier
    ds_read_b128 v[212:215], v18 offset:0
    ds_read_b128 v[216:219], v18 offset:8192
    ds_read_b128 v[220:223], v18 offset:16384
    ds_read_b128 v[224:227], v18 offset:24576
    s_cmp_eq_u32 s54, 0
    s_cselect_b32 s36, s27, s36
    v_and_b32 v98, 7, v1
    v_lshl_add_u32 v124, v98, 3, s19
    v_lshl_add_u32 v98, v98, 10, s40
    v_cndmask_b32 v124, v124, v98, s[14:15]
    s_mov_b32 s19, 0
    buffer_load_dwordx2 v[98:99], off, s[32:35], s36 sc1
    v_max3_f32 v232, v128, v129, v130
    v_max3_f32 v233, v131, v132, v133
    v_max3_f32 v232, v134, v135, v232
    v_max3_f32 v233, v136, v137, v233
    v_max3_f32 v232, v138, v139, v232
    v_max3_f32 v233, v140, v141, v233
    v_max3_f32 v232, v142, v143, v232
    v_max3_f32 v233, v106, v107, v233
    v_max_f32 v232, v232, v233
    v_mul_f32 v232, s22, v232
    v_fma_f32 v128, v128, s22, -v232
    v_fma_f32 v129, v129, s22, -v232
    s_waitcnt lgkmcnt(2)
    v_add_f32 v212, v212, v216
    s_waitcnt lgkmcnt(0)
    v_add_f32 v220, v220, v224
    v_add_f32 v213, v213, v217
    v_add_f32 v221, v221, v225
    v_add_f32 v214, v214, v218
    v_add_f32 v222, v222, v226
    v_add_f32 v215, v215, v219
    v_add_f32 v223, v223, v227
    v_add_f32 v212, v212, v220
    v_add_f32 v213, v213, v221
    v_add_f32 v214, v214, v222
    v_add_f32 v215, v215, v223
    v_min_u32 v212, -2, v212
    v_min_u32 v213, -2, v213
    v_min_u32 v214, -2, v214
    v_min_u32 v215, -2, v215
    buffer_store_dwordx4 v[212:215], v2, s[32:35], s37 offen sc1
    v_fma_f32 v130, v130, s22, -v232
    v_fma_f32 v131, v131, s22, -v232
    v_exp_f32 v128, v128
    v_exp_f32 v129, v129
    v_fma_f32 v132, v132, s22, -v232
    v_fma_f32 v133, v133, s22, -v232
    v_exp_f32 v130, v130
    v_exp_f32 v131, v131
    v_fma_f32 v134, v134, s22, -v232
    v_fma_f32 v135, v135, s22, -v232
    v_exp_f32 v132, v132
    v_exp_f32 v133, v133
    v_add_f32 v234, v128, v130
    v_add_f32 v235, v129, v131
    v_fma_f32 v136, v136, s22, -v232
    v_fma_f32 v137, v137, s22, -v232
    v_exp_f32 v134, v134
    v_exp_f32 v135, v135
    v_add_f32 v234, v234, v132
    v_add_f32 v235, v235, v133
    v_fma_f32 v138, v138, s22, -v232
    v_fma_f32 v139, v139, s22, -v232
    v_exp_f32 v136, v136
    v_exp_f32 v137, v137
    v_add_f32 v234, v234, v134
    v_add_f32 v235, v235, v135
    v_fma_f32 v140, v140, s22, -v232
    v_fma_f32 v141, v141, s22, -v232
    v_exp_f32 v138, v138
    v_exp_f32 v139, v139
    v_add_f32 v234, v234, v136
    v_add_f32 v235, v235, v137
    v_fma_f32 v142, v142, s22, -v232
    v_fma_f32 v143, v143, s22, -v232
    v_exp_f32 v140, v140
    v_exp_f32 v141, v141
    v_add_f32 v234, v234, v138
    v_add_f32 v235, v235, v139
    v_fma_f32 v106, v106, s22, -v232
    v_fma_f32 v107, v107, s22, -v232
    v_exp_f32 v142, v142
    v_exp_f32 v143, v143
    v_add_f32 v234, v234, v140
    v_add_f32 v235, v235, v141
    v_exp_f32 v106, v106
    v_exp_f32 v107, v107
    v_add_f32 v234, v234, v142
    v_add_f32 v235, v235, v143
    v_add_f32 v234, v234, v235
    v_add_f32 v235, v106, v107
    v_add_f32 v234, v234, v235
    v_rcp_f32 v232, v234
    s_nop 0
    v_mul_f32 v128, v128, v232
    v_mul_f32 v129, v129, v232
    v_cvt_pk_bf16_f32 v88, v128, v129
    v_mul_f32 v130, v130, v232
    v_mul_f32 v131, v131, v232
    v_cvt_pk_bf16_f32 v89, v130, v131
    v_mul_f32 v132, v132, v232
    v_mul_f32 v133, v133, v232
    v_cvt_pk_bf16_f32 v90, v132, v133
    v_mul_f32 v134, v134, v232
    v_mul_f32 v135, v135, v232
    v_cvt_pk_bf16_f32 v91, v134, v135
    v_mul_f32 v136, v136, v232
    v_mul_f32 v137, v137, v232
    v_cvt_pk_bf16_f32 v92, v136, v137
    v_mul_f32 v138, v138, v232
    v_mul_f32 v139, v139, v232
    v_cvt_pk_bf16_f32 v93, v138, v139
    v_mul_f32 v140, v140, v232
    v_mul_f32 v141, v141, v232
    v_cvt_pk_bf16_f32 v94, v140, v141
    v_mul_f32 v142, v142, v232
    v_mul_f32 v143, v143, v232
    v_cvt_pk_bf16_f32 v95, v142, v143
    v_mul_f32 v106, v106, v232
    v_mul_f32 v107, v107, v232
    v_cvt_pk_bf16_f32 v26, v106, v107
    s_cmp_eq_u32 s54, 0
    s_cbranch_scc1 ZPREV
    s_waitcnt vmcnt(1)
    v_cmp_ne_u64 vcc, s[56:57], v[98:99]
    s_cmp_eq_u64 vcc, 0
    s_cbranch_scc0 ol_10
pd_9:
    s_add_u32 s58, s26, s7
    s_mov_b32 m0, s7
    s_nop 0
    buffer_load_dwordx4 v2, s[32:35], s58 offen offset:0 sc1 lds
    buffer_load_dwordx4 v2, s[32:35], s58 offen offset:1024 sc1 lds
    s_mov_b32 exec_hi, 0
    buffer_load_dwordx4 v2, s[32:35], s58 offen offset:2048 sc1 lds
    s_mov_b32 exec_hi, -1
    s_add_u32 s58, s26, s8
    s_mov_b32 m0, s8
    s_nop 0
    buffer_load_dwordx4 v2, s[32:35], s58 offen offset:0 sc1 lds
    buffer_load_dwordx4 v2, s[32:35], s58 offen offset:1024 sc1 lds
    s_mov_b32 exec_hi, 0
    buffer_load_dwordx4 v2, s[32:35], s58 offen offset:2048 sc1 lds
    s_mov_b32 exec_hi, -1
PREVJ:
    ds_read_b128 v[128:131], v13 offset:20480
    ds_read_b128 v[132:135], v13 offset:20528
    ds_read_b64_tr_b16 v[136:137], v15 offset:20480
    ds_read_b64_tr_b16 v[138:139], v15 offset:21120
    s_waitcnt lgkmcnt(3)
    v_mfma_f32_32x32x16_bf16 v[188:203], v[128:131], v[76:79], v[40:55]
    s_waitcnt lgkmcnt(2)
    v_mfma_f32_32x32x16_bf16 v[188:203], v[132:135], v[34:37], v[188:203]
    ds_read_b128 v[128:131], v13 offset:17920
    ds_read_b128 v[132:135], v13 offset:17968
    s_nop 9
    v_exp_f32 v188, v188
    v_exp_f32 v189, v189
    v_exp_f32 v190, v190
    v_exp_f32 v191, v191
    v_cvt_pk_bf16_f32 v188, v188, v189
    v_exp_f32 v192, v192
    s_waitcnt lgkmcnt(1)
    v_mfma_f32_32x32x16_bf16 v[204:219], v[128:131], v[76:79], 0
    v_exp_f32 v193, v193
    v_exp_f32 v194, v194
    v_cvt_pk_bf16_f32 v189, v190, v191
    v_exp_f32 v195, v195
    s_waitcnt lgkmcnt(0)
    v_mfma_f32_32x32x16_bf16 v[204:219], v[132:135], v[34:37], v[204:219]
    v_cvt_pk_bf16_f32 v190, v192, v193
    ds_read_b64_tr_b16 v[140:141], v15 offset:21760
    ds_read_b64_tr_b16 v[142:143], v15 offset:22400
    v_cvt_pk_bf16_f32 v191, v194, v195
    v_exp_f32 v196, v196
    v_exp_f32 v197, v197
    v_mfma_f32_32x32x16_bf16 v[172:187], v[136:139], v[188:191], 0
    ds_read_b128 v[128:131], v13 offset:15360
    ds_read_b128 v[132:135], v13 offset:15408
    s_add_u32 s20, s2, 32768
    buffer_load_dwordx4 a[160:163], v2, s[32:35], s20 offen offset:0 sc1
    v_exp_f32 v198, v198
    v_exp_f32 v199, v199
    v_cvt_pk_bf16_f32 v192, v196, v197
    buffer_load_dwordx4 a[164:167], v2, s[32:35], s20 offen offset:1024 sc1
    ds_read_b64_tr_b16 v[136:137], v15 offset:17920
    ds_read_b64_tr_b16 v[138:139], v15 offset:18560
    v_exp_f32 v200, v200
    v_exp_f32 v201, v201
    buffer_load_dwordx4 a[168:171], v2, s[32:35], s20 offen offset:2048 sc1
    v_cvt_pk_bf16_f32 v193, v198, v199
    v_exp_f32 v202, v202
    v_exp_f32 v203, v203
    buffer_load_dwordx4 a[172:175], v2, s[32:35], s20 offen offset:3072 sc1
    v_cvt_pk_bf16_f32 v194, v200, v201
    v_cvt_pk_bf16_f32 v195, v202, v203
    v_exp_f32 v204, v204
    v_exp_f32 v205, v205
    s_waitcnt lgkmcnt(4)
    v_mfma_f32_32x32x16_bf16 v[172:187], v[140:143], v[192:195], v[172:187]
    v_exp_f32 v206, v206
    v_exp_f32 v207, v207
    v_cvt_pk_bf16_f32 v204, v204, v205
    v_exp_f32 v208, v208
    s_waitcnt lgkmcnt(3)
    v_mfma_f32_32x32x16_bf16 v[188:203], v[128:131], v[76:79], 0
    v_exp_f32 v209, v209
    v_exp_f32 v210, v210
    v_cvt_pk_bf16_f32 v205, v206, v207
    v_exp_f32 v211, v211
    s_waitcnt lgkmcnt(2)
    v_mfma_f32_32x32x16_bf16 v[188:203], v[132:135], v[34:37], v[188:203]
    v_cvt_pk_bf16_f32 v206, v208, v209
    ds_read_b64_tr_b16 v[140:141], v15 offset:19200
    ds_read_b64_tr_b16 v[142:143], v15 offset:19840
    v_cvt_pk_bf16_f32 v207, v210, v211
    v_exp_f32 v212, v212
    v_exp_f32 v213, v213
    s_waitcnt lgkmcnt(2)
    v_mfma_f32_32x32x16_bf16 v[172:187], v[136:139], v[204:207], v[172:187]
    ds_read_b128 v[128:131], v13 offset:12800
    ds_read_b128 v[132:135], v13 offset:12848
    s_add_u32 s20, s2, 36864
    buffer_load_dwordx4 a[176:179], v2, s[32:35], s20 offen offset:0 sc1
    v_exp_f32 v214, v214
    v_exp_f32 v215, v215
    v_cvt_pk_bf16_f32 v208, v212, v213
    buffer_load_dwordx4 a[180:183], v2, s[32:35], s20 offen offset:1024 sc1
    ds_read_b64_tr_b16 v[136:137], v15 offset:15360
    ds_read_b64_tr_b16 v[138:139], v15 offset:16000
    v_exp_f32 v216, v216
    v_exp_f32 v217, v217
    buffer_load_dwordx4 a[184:187], v2, s[32:35], s20 offen offset:2048 sc1
    v_cvt_pk_bf16_f32 v209, v214, v215
    v_exp_f32 v218, v218
    v_exp_f32 v219, v219
    buffer_load_dwordx4 a[188:191], v2, s[32:35], s20 offen offset:3072 sc1
    v_cvt_pk_bf16_f32 v210, v216, v217
    v_cvt_pk_bf16_f32 v211, v218, v219
    v_exp_f32 v188, v188
    v_exp_f32 v189, v189
    s_waitcnt lgkmcnt(4)
    v_mfma_f32_32x32x16_bf16 v[172:187], v[140:143], v[208:211], v[172:187]
    v_exp_f32 v190, v190
    v_exp_f32 v191, v191
    v_cvt_pk_bf16_f32 v188, v188, v189
    v_exp_f32 v192, v192
    s_waitcnt lgkmcnt(3)
    v_mfma_f32_32x32x16_bf16 v[204:219], v[128:131], v[76:79], 0
    v_exp_f32 v193, v193
    v_exp_f32 v194, v194
    v_cvt_pk_bf16_f32 v189, v190, v191
    v_exp_f32 v195, v195
    s_waitcnt lgkmcnt(2)
    v_mfma_f32_32x32x16_bf16 v[204:219], v[132:135], v[34:37], v[204:219]
    v_cvt_pk_bf16_f32 v190, v192, v193
    ds_read_b64_tr_b16 v[140:141], v15 offset:16640
    ds_read_b64_tr_b16 v[142:143], v15 offset:17280
    v_cvt_pk_bf16_f32 v191, v194, v195
    v_exp_f32 v196, v196
    v_exp_f32 v197, v197
    s_waitcnt lgkmcnt(2)
    v_mfma_f32_32x32x16_bf16 v[172:187], v[136:139], v[188:191], v[172:187]
    buffer_load_dwordx2 v[98:99], v124, s[32:35], s19 offen sc1
    ds_read_b128 v[128:131], v13 offset:10240
    ds_read_b128 v[132:135], v13 offset:10288
    s_add_u32 s20, s2, 40960
    buffer_load_dwordx4 a[192:195], v2, s[32:35], s20 offen offset:0 sc1
    v_exp_f32 v198, v198
    v_exp_f32 v199, v199
    v_cvt_pk_bf16_f32 v192, v196, v197
    buffer_load_dwordx4 a[196:199], v2, s[32:35], s20 offen offset:1024 sc1
    ds_read_b64_tr_b16 v[136:137], v15 offset:12800
    ds_read_b64_tr_b16 v[138:139], v15 offset:13440
    v_exp_f32 v200, v200
    v_exp_f32 v201, v201
    buffer_load_dwordx4 a[200:203], v2, s[32:35], s20 offen offset:2048 sc1
    v_cvt_pk_bf16_f32 v193, v198, v199
    v_exp_f32 v202, v202
    v_exp_f32 v203, v203
    buffer_load_dwordx4 a[204:207], v2, s[32:35], s20 offen offset:3072 sc1
    v_cvt_pk_bf16_f32 v194, v200, v201
    v_cvt_pk_bf16_f32 v195, v202, v203
    v_exp_f32 v204, v204
    v_exp_f32 v205, v205
    s_waitcnt lgkmcnt(4)
    v_mfma_f32_32x32x16_bf16 v[172:187], v[140:143], v[192:195], v[172:187]
    v_exp_f32 v206, v206
    v_exp_f32 v207, v207
    v_cvt_pk_bf16_f32 v204, v204, v205
    v_exp_f32 v208, v208
    s_waitcnt lgkmcnt(3)
    v_mfma_f32_32x32x16_bf16 v[188:203], v[128:131], v[76:79], 0
    v_exp_f32 v209, v209
    v_exp_f32 v210, v210
    v_cvt_pk_bf16_f32 v205, v206, v207
    v_exp_f32 v211, v211
    s_waitcnt lgkmcnt(2)
    v_mfma_f32_32x32x16_bf16 v[188:203], v[132:135], v[34:37], v[188:203]
    v_cvt_pk_bf16_f32 v206, v208, v209
    ds_read_b64_tr_b16 v[140:141], v15 offset:14080
    ds_read_b64_tr_b16 v[142:143], v15 offset:14720
    v_cvt_pk_bf16_f32 v207, v210, v211
    v_exp_f32 v212, v212
    v_exp_f32 v213, v213
    s_waitcnt lgkmcnt(2)
    v_mfma_f32_32x32x16_bf16 v[172:187], v[136:139], v[204:207], v[172:187]
    ds_read_b128 v[128:131], v12 offset:20480
    ds_read_b128 v[132:135], v12 offset:20528
    s_add_u32 s20, s2, 45056
    buffer_load_dwordx4 a[208:211], v2, s[32:35], s20 offen offset:0 sc1
    v_exp_f32 v214, v214
    v_exp_f32 v215, v215
    v_cvt_pk_bf16_f32 v208, v212, v213
    buffer_load_dwordx4 a[212:215], v2, s[32:35], s20 offen offset:1024 sc1
    ds_read_b64_tr_b16 v[136:137], v15 offset:10240
    ds_read_b64_tr_b16 v[138:139], v15 offset:10880
    v_exp_f32 v216, v216
    v_exp_f32 v217, v217
    buffer_load_dwordx4 a[216:219], v2, s[32:35], s20 offen offset:2048 sc1
    v_cvt_pk_bf16_f32 v209, v214, v215
    v_exp_f32 v218, v218
    v_exp_f32 v219, v219
    buffer_load_dwordx4 a[220:223], v2, s[32:35], s20 offen offset:3072 sc1
    v_cvt_pk_bf16_f32 v210, v216, v217
    v_cvt_pk_bf16_f32 v211, v218, v219
    v_exp_f32 v188, v188
    v_exp_f32 v189, v189
    s_waitcnt lgkmcnt(4)
    v_mfma_f32_32x32x16_bf16 v[172:187], v[140:143], v[208:211], v[172:187]
    v_exp_f32 v190, v190
    v_exp_f32 v191, v191
    v_cvt_pk_bf16_f32 v188, v188, v189
    v_exp_f32 v192, v192
    s_waitcnt lgkmcnt(3)
    v_mfma_f32_32x32x16_bf16 v[204:219], v[128:131], v[72:75], v[40:55]
    v_exp_f32 v193, v193
    v_exp_f32 v194, v194
    v_cvt_pk_bf16_f32 v189, v190, v191
    v_exp_f32 v195, v195
    s_waitcnt lgkmcnt(2)
    v_mfma_f32_32x32x16_bf16 v[204:219], v[132:135], v[30:33], v[204:219]
    v_cvt_pk_bf16_f32 v190, v192, v193
    ds_read_b64_tr_b16 v[140:141], v15 offset:11520
    ds_read_b64_tr_b16 v[142:143], v15 offset:12160
    v_cvt_pk_bf16_f32 v191, v194, v195
    v_exp_f32 v196, v196
    v_exp_f32 v197, v197
    s_waitcnt lgkmcnt(2)
    v_mfma_f32_32x32x16_bf16 v[172:187], v[136:139], v[188:191], v[172:187]
    s_waitcnt vmcnt(17)
    s_barrier
    s_waitcnt vmcnt(8)
    v_cmp_ne_u64 vcc, s[56:57], v[98:99]
    s_cmp_eq_u64 vcc, 0
    s_cbranch_scc0 ol_13
pd_12:
    ds_read_b128 v[128:131], v13 offset:7680
    ds_read_b128 v[132:135], v13 offset:7728
    buffer_load_dwordx4 v[240:243], v2, s[32:35], s39 offen offset:0 sc1
    buffer_load_dwordx4 v[244:247], v2, s[32:35], s39 offen offset:1024 sc1
    v_exp_f32 v198, v198
    v_exp_f32 v199, v199
    v_cvt_pk_bf16_f32 v192, v196, v197
    buffer_load_dwordx4 v[248:251], v2, s[32:35], s39 offen offset:2048 sc1
    buffer_load_dwordx4 v[252:255], v2, s[32:35], s39 offen offset:3072 sc1
    ds_read_b64_tr_b16 v[136:137], v14 offset:20480
    ds_read_b64_tr_b16 v[138:139], v14 offset:21120
    v_exp_f32 v200, v200
    v_exp_f32 v201, v201
    buffer_load_dwordx4 v[108:111], v7, s[32:35], s39 offen offset:0 sc1
    buffer_load_dwordx4 v[112:115], v7, s[32:35], s39 offen offset:1024 sc1
    v_cvt_pk_bf16_f32 v193, v198, v199
    v_exp_f32 v202, v202
    v_exp_f32 v203, v203
    buffer_load_dwordx4 v[116:119], v7, s[32:35], s39 offen offset:2048 sc1
    buffer_load_dwordx4 v[120:123], v7, s[32:35], s39 offen offset:3072 sc1
    v_cvt_pk_bf16_f32 v194, v200, v201
    v_cvt_pk_bf16_f32 v195, v202, v203
    v_exp_f32 v204, v204
    v_exp_f32 v205, v205
    s_waitcnt lgkmcnt(4)
    v_mfma_f32_32x32x16_bf16 v[172:187], v[140:143], v[192:195], v[172:187]
    v_exp_f32 v206, v206
    v_exp_f32 v207, v207
    v_cvt_pk_bf16_f32 v204, v204, v205
    v_exp_f32 v208, v208
    s_waitcnt lgkmcnt(3)
    v_mfma_f32_32x32x16_bf16 v[188:203], v[128:131], v[76:79], 0
    v_exp_f32 v209, v209
    v_exp_f32 v210, v210
    v_cvt_pk_bf16_f32 v205, v206, v207
    v_exp_f32 v211, v211
    s_waitcnt lgkmcnt(2)
    v_mfma_f32_32x32x16_bf16 v[188:203], v[132:135], v[34:37], v[188:203]
    v_cvt_pk_bf16_f32 v206, v208, v209
    ds_read_b64_tr_b16 v[140:141], v14 offset:21760
    ds_read_b64_tr_b16 v[142:143], v14 offset:22400
    v_cvt_pk_bf16_f32 v207, v210, v211
    v_exp_f32 v212, v212
    v_exp_f32 v213, v213
    s_waitcnt lgkmcnt(2)
    v_mfma_f32_32x32x16_bf16 v[156:171], v[136:139], v[204:207], 0
    ds_read_b128 v[128:131], v13 offset:5120
    ds_read_b128 v[132:135], v13 offset:5168
    s_add_u32 s20, s2, 49152
    buffer_load_dwordx4 a[224:227], v2, s[32:35], s20 offen offset:0 sc1
    v_exp_f32 v214, v214
    v_exp_f32 v215, v215
    v_cvt_pk_bf16_f32 v208, v212, v213
    buffer_load_dwordx4 a[228:231], v2, s[32:35], s20 offen offset:1024 sc1
    ds_read_b64_tr_b16 v[136:137], v15 offset:7680
    ds_read_b64_tr_b16 v[138:139], v15 offset:8320
    v_exp_f32 v216, v216
    v_exp_f32 v217, v217
    buffer_load_dwordx4 a[232:235], v2, s[32:35], s20 offen offset:2048 sc1
    v_cvt_pk_bf16_f32 v209, v214, v215
    v_exp_f32 v218, v218
    v_exp_f32 v219, v219
    buffer_load_dwordx4 a[236:239], v2, s[32:35], s20 offen offset:3072 sc1
    v_cvt_pk_bf16_f32 v210, v216, v217
    v_cvt_pk_bf16_f32 v211, v218, v219
    v_exp_f32 v188, v188
    v_exp_f32 v189, v189
    s_waitcnt lgkmcnt(4)
    v_mfma_f32_32x32x16_bf16 v[156:171], v[140:143], v[208:211], v[156:171]
    v_exp_f32 v190, v190
    v_exp_f32 v191, v191
    v_cvt_pk_bf16_f32 v188, v188, v189
    v_exp_f32 v192, v192
    s_waitcnt lgkmcnt(3)
    v_mfma_f32_32x32x16_bf16 v[204:219], v[128:131], v[76:79], 0
    v_exp_f32 v193, v193
    v_exp_f32 v194, v194
    v_cvt_pk_bf16_f32 v189, v190, v191
    v_exp_f32 v195, v195
    s_waitcnt lgkmcnt(2)
    v_mfma_f32_32x32x16_bf16 v[204:219], v[132:135], v[34:37], v[204:219]
    v_cvt_pk_bf16_f32 v190, v192, v193
    ds_read_b64_tr_b16 v[140:141], v15 offset:8960
    ds_read_b64_tr_b16 v[142:143], v15 offset:9600
    v_cvt_pk_bf16_f32 v191, v194, v195
    v_exp_f32 v196, v196
    v_exp_f32 v197, v197
    s_waitcnt lgkmcnt(2)
    v_mfma_f32_32x32x16_bf16 v[172:187], v[136:139], v[188:191], v[172:187]
    ds_read_b128 v[128:131], v13 offset:2560
    ds_read_b128 v[132:135], v13 offset:2608
    s_add_u32 s20, s2, 53248
    buffer_load_dwordx4 a[240:243], v2, s[32:35], s20 offen offset:0 sc1
    v_exp_f32 v198, v198
    v_exp_f32 v199, v199
    v_cvt_pk_bf16_f32 v192, v196, v197
    buffer_load_dwordx4 a[244:247], v2, s[32:35], s20 offen offset:1024 sc1
    ds_read_b64_tr_b16 v[136:137], v15 offset:5120
    ds_read_b64_tr_b16 v[138:139], v15 offset:5760
    v_exp_f32 v200, v200
    v_exp_f32 v201, v201
    buffer_load_dwordx4 a[248:251], v2, s[32:35], s20 offen offset:2048 sc1
    v_cvt_pk_bf16_f32 v193, v198, v199
    v_exp_f32 v202, v202
    v_exp_f32 v203, v203
    buffer_load_dwordx4 a[252:255], v2, s[32:35], s20 offen offset:3072 sc1
    v_cvt_pk_bf16_f32 v194, v200, v201
    v_cvt_pk_bf16_f32 v195, v202, v203
    v_exp_f32 v204, v204
    v_exp_f32 v205, v205
    s_waitcnt lgkmcnt(4)
    v_mfma_f32_32x32x16_bf16 v[172:187], v[140:143], v[192:195], v[172:187]
    v_exp_f32 v206, v206
    v_exp_f32 v207, v207
    v_cvt_pk_bf16_f32 v204, v204, v205
    v_exp_f32 v208, v208
    s_waitcnt lgkmcnt(3)
    v_mfma_f32_32x32x16_bf16 v[188:203], v[128:131], v[76:79], 0
    v_exp_f32 v209, v209
    v_exp_f32 v210, v210
    v_cvt_pk_bf16_f32 v205, v206, v207
    v_exp_f32 v211, v211
    s_waitcnt lgkmcnt(2)
    v_mfma_f32_32x32x16_bf16 v[188:203], v[132:135], v[34:37], v[188:203]
    v_cvt_pk_bf16_f32 v206, v208, v209
    ds_read_b64_tr_b16 v[140:141], v15 offset:6400
    ds_read_b64_tr_b16 v[142:143], v15 offset:7040
    v_cvt_pk_bf16_f32 v207, v210, v211
    v_exp_f32 v212, v212
    v_exp_f32 v213, v213
    s_waitcnt lgkmcnt(2)
    v_mfma_f32_32x32x16_bf16 v[172:187], v[136:139], v[204:207], v[172:187]
    s_waitcnt vmcnt(15)
    v_max3_u32 v236, v240, v241, v240
    v_max3_u32 v237, v242, v243, v242
    s_waitcnt vmcnt(14)
    v_max3_u32 v236, v244, v245, v236
    v_max3_u32 v237, v246, v247, v237
    s_waitcnt vmcnt(13)
    v_max3_u32 v236, v248, v249, v236
    v_max3_u32 v237, v250, v251, v237
    s_waitcnt vmcnt(12)
    v_max3_u32 v236, v252, v253, v236
    v_max3_u32 v237, v254, v255, v237
    s_waitcnt vmcnt(11)
    v_max3_u32 v236, v108, v109, v236
    v_max3_u32 v237, v110, v111, v237
    s_waitcnt vmcnt(10)
    v_max3_u32 v236, v112, v113, v236
    v_max3_u32 v237, v114, v115, v237
    s_waitcnt vmcnt(9)
    v_max3_u32 v236, v116, v117, v236
    v_max3_u32 v237, v118, v119, v237
    s_waitcnt vmcnt(8)
    v_max3_u32 v236, v120, v121, v236
    v_max3_u32 v237, v122, v123, v237
    v_max_u32 v236, v236, v237
    v_cmp_eq_u32 vcc, -1, v236
    s_cmp_eq_u64 vcc, 0
    s_cbranch_scc0 ol_16
dd_15:
    v_add_f32 v240, v240, v108
    v_add_f32 v241, v241, v109
    v_add_f32 v242, v242, v110
    v_add_f32 v243, v243, v111
    v_add_f32 v244, v244, v112
    v_add_f32 v245, v245, v113
    v_add_f32 v246, v246, v114
    v_add_f32 v247, v247, v115
    v_add_f32 v248, v248, v116
    v_add_f32 v249, v249, v117
    v_add_f32 v250, v250, v118
    v_add_f32 v251, v251, v119
    v_add_f32 v252, v252, v120
    v_add_f32 v253, v253, v121
    v_add_f32 v254, v254, v122
    v_add_f32 v255, v255, v123
    v_add_f32 v240, v240, v248
    v_add_f32 v241, v241, v249
    v_add_f32 v242, v242, v250
    v_add_f32 v243, v243, v251
    v_add_f32 v244, v244, v252
    v_add_f32 v245, v245, v253
    v_add_f32 v246, v246, v254
    v_add_f32 v247, v247, v255
    v_add_f32 v240, v240, v244
    v_add_f32 v241, v241, v245
    v_add_f32 v242, v242, v246
    v_add_f32 v243, v243, v247
    v_cvt_pk_bf16_f32 v240, v240, v241
    v_cvt_pk_bf16_f32 v241, v242, v243
    v_add_u32 v17, s6, v2
    ds_write_b64 v17, v[240:241]
    ds_read_b128 v[128:131], v13 offset:0
    ds_read_b128 v[132:135], v13 offset:48
    s_add_u32 s20, s2, 57344
    buffer_load_dwordx4 a[0:3], v2, s[32:35], s20 offen offset:0 sc1
    v_exp_f32 v214, v214
    v_exp_f32 v215, v215
    v_cvt_pk_bf16_f32 v208, v212, v213
    buffer_load_dwordx4 a[4:7], v2, s[32:35], s20 offen offset:1024 sc1
    ds_read_b64_tr_b16 v[136:137], v15 offset:2560
    ds_read_b64_tr_b16 v[138:139], v15 offset:3200
    v_exp_f32 v216, v216
    v_exp_f32 v217, v217
    buffer_load_dwordx4 a[8:11], v2, s[32:35], s20 offen offset:2048 sc1
    v_cvt_pk_bf16_f32 v209, v214, v215
    v_exp_f32 v218, v218
    v_exp_f32 v219, v219
    buffer_load_dwordx4 a[12:15], v2, s[32:35], s20 offen offset:3072 sc1
    v_cvt_pk_bf16_f32 v210, v216, v217
    v_cvt_pk_bf16_f32 v211, v218, v219
    v_exp_f32 v188, v188
    v_exp_f32 v189, v189
    s_waitcnt lgkmcnt(5)
    v_mfma_f32_32x32x16_bf16 v[172:187], v[140:143], v[208:211], v[172:187]
    v_exp_f32 v190, v190
    v_exp_f32 v191, v191
    v_cvt_pk_bf16_f32 v188, v188, v189
    v_exp_f32 v192, v192
    s_waitcnt lgkmcnt(3)
    v_mfma_f32_32x32x16_bf16 v[204:219], v[128:131], v[76:79], v[56:71]
    v_exp_f32 v193, v193
    v_exp_f32 v194, v194
    v_cvt_pk_bf16_f32 v189, v190, v191
    v_exp_f32 v195, v195
    s_waitcnt lgkmcnt(2)
    v_mfma_f32_32x32x16_bf16 v[204:219], v[132:135], v[34:37], v[204:219]
    v_cvt_pk_bf16_f32 v190, v192, v193
    ds_read_b64_tr_b16 v[140:141], v15 offset:3840
    ds_read_b64_tr_b16 v[142:143], v15 offset:4480
    v_cvt_pk_bf16_f32 v191, v194, v195
    v_exp_f32 v196, v196
    v_exp_f32 v197, v197
    s_waitcnt lgkmcnt(2)
    v_mfma_f32_32x32x16_bf16 v[172:187], v[136:139], v[188:191], v[172:187]
    s_barrier
    ds_read_b128 v[240:243], v38 offset:0
    ds_read_b128 v[244:247], v38 offset:1024
    ds_read_b32 v248, v39
    v_mov_b32 v249, 0
    v_mov_b32 v250, 0
    v_mov_b32 v251, 0
    ds_read_b128 v[128:131], v12 offset:17920
    ds_read_b128 v[132:135], v12 offset:17968
    v_exp_f32 v198, v198
    v_exp_f32 v199, v199
    v_cvt_pk_bf16_f32 v192, v196, v197
    ds_read_b64_tr_b16 v[136:137], v15 offset:0
    ds_read_b64_tr_b16 v[138:139], v15 offset:640
    v_exp_f32 v200, v200
    v_exp_f32 v201, v201
    s_waitcnt lgkmcnt(6)
    v_mfma_f32_32x32x16_bf16 v[220:235], v[240:243], v[88:91], 0
    v_cvt_pk_bf16_f32 v193, v198, v199
    v_exp_f32 v202, v202
    v_exp_f32 v203, v203
    v_mfma_f32_32x32x16_bf16 v[100:115], v[240:243], v[80:83], 0
    v_cvt_pk_bf16_f32 v194, v200, v201
    v_cvt_pk_bf16_f32 v195, v202, v203
    v_exp_f32 v204, v204
    v_exp_f32 v205, v205
    v_mfma_f32_32x32x16_bf16 v[172:187], v[140:143], v[192:195], v[172:187]
    v_exp_f32 v206, v206
    v_exp_f32 v207, v207
    v_cvt_pk_bf16_f32 v204, v204, v205
    v_exp_f32 v208, v208
    s_waitcnt lgkmcnt(3)
    v_mfma_f32_32x32x16_bf16 v[188:203], v[128:131], v[72:75], 0
    v_exp_f32 v209, v209
    v_exp_f32 v210, v210
    v_cvt_pk_bf16_f32 v205, v206, v207
    v_exp_f32 v211, v211
    s_waitcnt lgkmcnt(2)
    v_mfma_f32_32x32x16_bf16 v[188:203], v[132:135], v[30:33], v[188:203]
    v_cvt_pk_bf16_f32 v206, v208, v209
    ds_read_b64_tr_b16 v[140:141], v15 offset:1280
    ds_read_b64_tr_b16 v[142:143], v15 offset:1920
    v_cvt_pk_bf16_f32 v207, v210, v211
    v_exp_f32 v212, v212
    v_exp_f32 v213, v213
    s_waitcnt lgkmcnt(2)
    v_mfma_f32_32x32x16_bf16 v[172:187], v[136:139], v[204:207], v[172:187]
    ds_read_b128 v[128:131], v12 offset:15360
    ds_read_b128 v[132:135], v12 offset:15408
    v_mfma_f32_32x32x16_bf16 v[220:235], v[244:247], v[92:95], v[220:235]
    v_exp_f32 v214, v214
    v_exp_f32 v215, v215
    v_cvt_pk_bf16_f32 v208, v212, v213
    v_mfma_f32_32x32x16_bf16 v[100:115], v[244:247], v[84:87], v[100:115]
    ds_read_b64_tr_b16 v[136:137], v14 offset:17920
    ds_read_b64_tr_b16 v[138:139], v14 offset:18560
    v_exp_f32 v216, v216
    v_exp_f32 v217, v217
    v_mfma_f32_32x32x16_bf16 v[220:235], v[248:251], v[26:29], v[220:235]
    v_cvt_pk_bf16_f32 v209, v214, v215
    v_exp_f32 v218, v218
    v_exp_f32 v219, v219
    v_mfma_f32_32x32x16_bf16 v[100:115], v[248:251], v[22:25], v[100:115]
    v_cvt_pk_bf16_f32 v210, v216, v217
    v_cvt_pk_bf16_f32 v211, v218, v219
    v_exp_f32 v188, v188
    v_exp_f32 v189, v189
    s_waitcnt lgkmcnt(4)
    v_mfma_f32_32x32x16_bf16 v[172:187], v[140:143], v[208:211], v[172:187]
    v_exp_f32 v190, v190
    v_exp_f32 v191, v191
    v_cvt_pk_bf16_f32 v188, v188, v189
    v_exp_f32 v192, v192
    s_waitcnt lgkmcnt(3)
    v_mfma_f32_32x32x16_bf16 v[204:219], v[128:131], v[72:75], 0
    v_exp_f32 v193, v193
    v_exp_f32 v194, v194
    v_cvt_pk_bf16_f32 v189, v190, v191
    v_exp_f32 v195, v195
    s_waitcnt lgkmcnt(2)
    v_mfma_f32_32x32x16_bf16 v[204:219], v[132:135], v[30:33], v[204:219]
    v_cvt_pk_bf16_f32 v190, v192, v193
    ds_read_b64_tr_b16 v[140:141], v14 offset:19200
    ds_read_b64_tr_b16 v[142:143], v14 offset:19840
    v_cvt_pk_bf16_f32 v191, v194, v195
    v_exp_f32 v196, v196
    v_exp_f32 v197, v197
    s_waitcnt lgkmcnt(2)
    v_mfma_f32_32x32x16_bf16 v[156:171], v[136:139], v[188:191], v[156:171]
    v_add_f32 v238, 0x358637bd, v232
    v_rcp_f32 v238, v238
    s_nop 0
    v_mul_f32 v238, v238, v97
    v_mul_f32 v220, v220, v238
    v_mul_f32 v221, v221, v238
    v_mul_f32 v222, v222, v238
    v_mul_f32 v223, v223, v238
    v_mul_f32 v224, v224, v238
    v_mul_f32 v225, v225, v238
    v_mul_f32 v226, v226, v238
    v_mul_f32 v227, v227, v238
    v_mul_f32 v230, v230, v238
    v_mul_f32 v231, v231, v238
    v_cvt_pk_bf16_f32 v232, v220, v221
    v_cvt_pk_bf16_f32 v233, v222, v223
    v_cvt_pk_bf16_f32 v234, v224, v225
    v_cvt_pk_bf16_f32 v235, v226, v227
    buffer_store_dwordx4 v[232:235], v0, s[32:35], s41 offen offset:0 sc1
    v_cvt_pk_bf16_f32 v146, v230, v231
    v_add_f32 v238, 0x358637bd, v112
    v_rcp_f32 v238, v238
    s_nop 0
    v_mul_f32 v238, v238, v96
    v_mul_f32 v100, v100, v238
    v_mul_f32 v101, v101, v238
    v_mul_f32 v102, v102, v238
    v_mul_f32 v103, v103, v238
    v_mul_f32 v104, v104, v238
    v_mul_f32 v105, v105, v238
    v_mul_f32 v106, v106, v238
    v_mul_f32 v107, v107, v238
    v_mul_f32 v110, v110, v238
    v_mul_f32 v111, v111, v238
    v_cvt_pk_bf16_f32 v112, v100, v101
    v_cvt_pk_bf16_f32 v113, v102, v103
    v_cvt_pk_bf16_f32 v114, v104, v105
    v_cvt_pk_bf16_f32 v115, v106, v107
    buffer_store_dwordx4 v[112:115], v0, s[32:35], s41 offen offset:1024 sc1
    v_cvt_pk_bf16_f32 v144, v110, v111
    s_mov_b32 s59, 0x28000000
    v_subrev_u32 v236, 0x2b800000, v184
    v_cmp_le_u32 vcc, s59, v236
    s_or_b32 s21, vcc_lo, vcc_hi
    s_cselect_b32 s61, 268435456, 0
    v_add_u32 v239, s61, v0
    v_rcp_f32 v236, v184
    v_sub_f32 v237, 1.0, v97
    v_mul_f32 v236, v236, v237
    v_mul_f32 v172, v172, v236
    v_mul_f32 v173, v173, v236
    v_mul_f32 v174, v174, v236
    v_mul_f32 v175, v175, v236
    v_mul_f32 v176, v176, v236
    v_mul_f32 v177, v177, v236
    v_mul_f32 v178, v178, v236
    v_mul_f32 v179, v179, v236
    v_mul_f32 v182, v182, v236
    v_mul_f32 v183, v183, v236
    v_cvt_pk_bf16_f32 v184, v172, v173
    v_cvt_pk_bf16_f32 v185, v174, v175
    v_cvt_pk_bf16_f32 v186, v176, v177
    v_cvt_pk_bf16_f32 v187, v178, v179
    buffer_store_dwordx4 v[184:187], v239, s[32:35], s42 offen offset:0 sc1
    v_cvt_pk_bf16_f32 v147, v182, v183
    v_add_u32 v237, s61, v8
    s_mov_b32 exec_hi, 0
    buffer_store_dwordx2 v[146:147], v237, s[32:35], s11 offen sc1
    s_mov_b32 exec_hi, -1
    ds_read_b128 v[128:131], v12 offset:12800
    ds_read_b128 v[132:135], v12 offset:12848
    s_add_u32 s20, s2, 61440
    buffer_load_dwordx4 a[16:19], v2, s[32:35], s20 offen offset:0 sc1
    v_exp_f32 v198, v198
    v_exp_f32 v199, v199
    v_cvt_pk_bf16_f32 v192, v196, v197
    buffer_load_dwordx4 a[20:23], v2, s[32:35], s20 offen offset:1024 sc1
    ds_read_b64_tr_b16 v[136:137], v14 offset:15360
    ds_read_b64_tr_b16 v[138:139], v14 offset:16000
    v_exp_f32 v200, v200
    v_exp_f32 v201, v201
    buffer_load_dwordx4 a[24:27], v2, s[32:35], s20 offen offset:2048 sc1
    v_cvt_pk_bf16_f32 v193, v198, v199
    v_exp_f32 v202, v202
    v_exp_f32 v203, v203
    buffer_load_dwordx4 a[28:31], v2, s[32:35], s20 offen offset:3072 sc1
    v_cvt_pk_bf16_f32 v194, v200, v201
    v_cvt_pk_bf16_f32 v195, v202, v203
    v_exp_f32 v204, v204
    v_exp_f32 v205, v205
    s_waitcnt lgkmcnt(4)
    v_mfma_f32_32x32x16_bf16 v[156:171], v[140:143], v[192:195], v[156:171]
    v_exp_f32 v206, v206
    v_exp_f32 v207, v207
    v_cvt_pk_bf16_f32 v204, v204, v205
    v_exp_f32 v208, v208
    s_waitcnt lgkmcnt(3)
    v_mfma_f32_32x32x16_bf16 v[188:203], v[128:131], v[72:75], 0
    v_exp_f32 v209, v209
    v_exp_f32 v210, v210
    v_cvt_pk_bf16_f32 v205, v206, v207
    v_exp_f32 v211, v211
    s_waitcnt lgkmcnt(2)
    v_mfma_f32_32x32x16_bf16 v[188:203], v[132:135], v[30:33], v[188:203]
    v_cvt_pk_bf16_f32 v206, v208, v209
    ds_read_b64_tr_b16 v[140:141], v14 offset:16640
    ds_read_b64_tr_b16 v[142:143], v14 offset:17280
    v_cvt_pk_bf16_f32 v207, v210, v211
    v_exp_f32 v212, v212
    v_exp_f32 v213, v213
    s_waitcnt lgkmcnt(2)
    v_mfma_f32_32x32x16_bf16 v[156:171], v[136:139], v[204:207], v[156:171]
    ds_read_b128 v[128:131], v12 offset:10240
    ds_read_b128 v[132:135], v12 offset:10288
    v_exp_f32 v214, v214
    v_exp_f32 v215, v215
    v_cvt_pk_bf16_f32 v208, v212, v213
    ds_read_b64_tr_b16 v[136:137], v14 offset:12800
    ds_read_b64_tr_b16 v[138:139], v14 offset:13440
    v_exp_f32 v216, v216
    v_exp_f32 v217, v217
    v_cvt_pk_bf16_f32 v209, v214, v215
    v_exp_f32 v218, v218
    v_exp_f32 v219, v219
    v_cvt_pk_bf16_f32 v210, v216, v217
    v_cvt_pk_bf16_f32 v211, v218, v219
    v_exp_f32 v188, v188
    v_exp_f32 v189, v189
    s_waitcnt lgkmcnt(4)
    v_mfma_f32_32x32x16_bf16 v[156:171], v[140:143], v[208:211], v[156:171]
    v_exp_f32 v190, v190
    v_exp_f32 v191, v191
    v_cvt_pk_bf16_f32 v188, v188, v189
    v_exp_f32 v192, v192
    s_waitcnt lgkmcnt(3)
    v_mfma_f32_32x32x16_bf16 v[204:219], v[128:131], v[72:75], 0
    v_exp_f32 v193, v193
    v_exp_f32 v194, v194
    v_cvt_pk_bf16_f32 v189, v190, v191
    v_exp_f32 v195, v195
    s_waitcnt lgkmcnt(2)
    v_mfma_f32_32x32x16_bf16 v[204:219], v[132:135], v[30:33], v[204:219]
    v_cvt_pk_bf16_f32 v190, v192, v193
    ds_read_b64_tr_b16 v[140:141], v14 offset:14080
    ds_read_b64_tr_b16 v[142:143], v14 offset:14720
    v_cvt_pk_bf16_f32 v191, v194, v195
    v_exp_f32 v196, v196
    v_exp_f32 v197, v197
    s_waitcnt lgkmcnt(2)
    v_mfma_f32_32x32x16_bf16 v[156:171], v[136:139], v[188:191], v[156:171]
    s_add_u32 s48, s18, 0
    s_add_u32 s49, s18, 4096
    s_add_u32 s50, s18, 8192
    s_add_u32 s51, s18, 13312
    ds_read_b128 v[128:131], v12 offset:7680
    ds_read_b128 v[132:135], v12 offset:7728
    v_exp_f32 v198, v198
    v_exp_f32 v199, v199
    v_cvt_pk_bf16_f32 v192, v196, v197
    ds_read_b64_tr_b16 v[136:137], v14 offset:10240
    ds_read_b64_tr_b16 v[138:139], v14 offset:10880
    v_exp_f32 v200, v200
    v_exp_f32 v201, v201
    v_cvt_pk_bf16_f32 v193, v198, v199
    v_exp_f32 v202, v202
    v_exp_f32 v203, v203
    v_cvt_pk_bf16_f32 v194, v200, v201
    v_cvt_pk_bf16_f32 v195, v202, v203
    v_exp_f32 v204, v204
    v_exp_f32 v205, v205
    s_waitcnt lgkmcnt(4)
    v_mfma_f32_32x32x16_bf16 v[156:171], v[140:143], v[192:195], v[156:171]
    v_exp_f32 v206, v206
    v_exp_f32 v207, v207
    v_cvt_pk_bf16_f32 v204, v204, v205
    v_exp_f32 v208, v208
    s_waitcnt lgkmcnt(3)
    v_mfma_f32_32x32x16_bf16 v[188:203], v[128:131], v[72:75], 0
    v_exp_f32 v209, v209
    v_exp_f32 v210, v210
    v_cvt_pk_bf16_f32 v205, v206, v207
    v_exp_f32 v211, v211
    s_waitcnt lgkmcnt(2)
    v_mfma_f32_32x32x16_bf16 v[188:203], v[132:135], v[30:33], v[188:203]
    v_cvt_pk_bf16_f32 v206, v208, v209
    ds_read_b64_tr_b16 v[140:141], v14 offset:11520
    ds_read_b64_tr_b16 v[142:143], v14 offset:12160
    v_cvt_pk_bf16_f32 v207, v210, v211
    v_exp_f32 v212, v212
    v_exp_f32 v213, v213
    s_waitcnt lgkmcnt(2)
    v_mfma_f32_32x32x16_bf16 v[156:171], v[136:139], v[204:207], v[156:171]
    ds_read_b128 v[128:131], v12 offset:5120
    ds_read_b128 v[132:135], v12 offset:5168
    v_exp_f32 v214, v214
    v_exp_f32 v215, v215
    v_cvt_pk_bf16_f32 v208, v212, v213
    ds_read_b64_tr_b16 v[136:137], v14 offset:7680
    ds_read_b64_tr_b16 v[138:139], v14 offset:8320
    v_exp_f32 v216, v216
    v_exp_f32 v217, v217
    v_cvt_pk_bf16_f32 v209, v214, v215
    v_exp_f32 v218, v218
    v_exp_f32 v219, v219
    v_cvt_pk_bf16_f32 v210, v216, v217
    v_cvt_pk_bf16_f32 v211, v218, v219
    v_exp_f32 v188, v188
    v_exp_f32 v189, v189
    s_waitcnt lgkmcnt(4)
    v_mfma_f32_32x32x16_bf16 v[156:171], v[140:143], v[208:211], v[156:171]
    v_exp_f32 v190, v190
    v_exp_f32 v191, v191
    v_cvt_pk_bf16_f32 v188, v188, v189
    v_exp_f32 v192, v192
    s_waitcnt lgkmcnt(3)
    v_mfma_f32_32x32x16_bf16 v[204:219], v[128:131], v[72:75], 0
    v_exp_f32 v193, v193
    v_exp_f32 v194, v194
    v_cvt_pk_bf16_f32 v189, v190, v191
    v_exp_f32 v195, v195
    s_waitcnt lgkmcnt(2)
    v_mfma_f32_32x32x16_bf16 v[204:219], v[132:135], v[30:33], v[204:219]
    v_cvt_pk_bf16_f32 v190, v192, v193
    ds_read_b64_tr_b16 v[140:141], v14 offset:8960
    ds_read_b64_tr_b16 v[142:143], v14 offset:9600
    v_cvt_pk_bf16_f32 v191, v194, v195
    v_exp_f32 v196, v196
    v_exp_f32 v197, v197
    s_waitcnt lgkmcnt(2)
    v_mfma_f32_32x32x16_bf16 v[156:171], v[136:139], v[188:191], v[156:171]
    ds_read_b128 v[128:131], v12 offset:2560
    ds_read_b128 v[132:135], v12 offset:2608
    buffer_load_dwordx4 v[220:223], v2, s[32:35], s48 offen offset:0 sc1
    buffer_load_dwordx4 v[240:243], v2, s[32:35], s49 offen offset:0 sc1
    v_exp_f32 v198, v198
    v_exp_f32 v199, v199
    v_cvt_pk_bf16_f32 v192, v196, v197
    buffer_load_dwordx4 v[224:227], v2, s[32:35], s48 offen offset:1024 sc1
    buffer_load_dwordx4 v[244:247], v2, s[32:35], s49 offen offset:1024 sc1
    ds_read_b64_tr_b16 v[136:137], v14 offset:5120
    ds_read_b64_tr_b16 v[138:139], v14 offset:5760
    v_exp_f32 v200, v200
    v_exp_f32 v201, v201
    buffer_load_dwordx4 v[228:231], v2, s[32:35], s48 offen offset:2048 sc1
    buffer_load_dwordx4 v[248:251], v2, s[32:35], s49 offen offset:2048 sc1
    v_cvt_pk_bf16_f32 v193, v198, v199
    v_exp_f32 v202, v202
    v_exp_f32 v203, v203
    buffer_load_dwordx4 v[232:235], v2, s[32:35], s48 offen offset:3072 sc1
    buffer_load_dwordx4 v[252:255], v2, s[32:35], s49 offen offset:3072 sc1
    v_cvt_pk_bf16_f32 v194, v200, v201
    v_cvt_pk_bf16_f32 v195, v202, v203
    v_exp_f32 v204, v204
    v_exp_f32 v205, v205
    s_waitcnt lgkmcnt(4)
    v_mfma_f32_32x32x16_bf16 v[156:171], v[140:143], v[192:195], v[156:171]
    v_exp_f32 v206, v206
    v_exp_f32 v207, v207
    v_cvt_pk_bf16_f32 v204, v204, v205
    v_exp_f32 v208, v208
    s_waitcnt lgkmcnt(3)
    v_mfma_f32_32x32x16_bf16 v[188:203], v[128:131], v[72:75], 0
    v_exp_f32 v209, v209
    v_exp_f32 v210, v210
    v_cvt_pk_bf16_f32 v205, v206, v207
    v_exp_f32 v211, v211
    s_waitcnt lgkmcnt(2)
    v_mfma_f32_32x32x16_bf16 v[188:203], v[132:135], v[30:33], v[188:203]
    v_cvt_pk_bf16_f32 v206, v208, v209
    ds_read_b64_tr_b16 v[140:141], v14 offset:6400
    ds_read_b64_tr_b16 v[142:143], v14 offset:7040
    v_cvt_pk_bf16_f32 v207, v210, v211
    v_exp_f32 v212, v212
    v_exp_f32 v213, v213
    s_waitcnt lgkmcnt(2)
    v_mfma_f32_32x32x16_bf16 v[156:171], v[136:139], v[204:207], v[156:171]
    ds_read_b128 v[128:131], v12 offset:0
    ds_read_b128 v[132:135], v12 offset:48
    v_exp_f32 v214, v214
    v_exp_f32 v215, v215
    v_cvt_pk_bf16_f32 v208, v212, v213
    ds_read_b64_tr_b16 v[136:137], v14 offset:2560
    ds_read_b64_tr_b16 v[138:139], v14 offset:3200
    v_exp_f32 v216, v216
    v_exp_f32 v217, v217
    v_cvt_pk_bf16_f32 v209, v214, v215
    v_exp_f32 v218, v218
    v_exp_f32 v219, v219
    v_cvt_pk_bf16_f32 v210, v216, v217
    v_cvt_pk_bf16_f32 v211, v218, v219
    v_exp_f32 v188, v188
    v_exp_f32 v189, v189
    s_waitcnt lgkmcnt(4)
    v_mfma_f32_32x32x16_bf16 v[156:171], v[140:143], v[208:211], v[156:171]
    v_exp_f32 v190, v190
    v_exp_f32 v191, v191
    v_cvt_pk_bf16_f32 v188, v188, v189
    v_exp_f32 v192, v192
    s_waitcnt lgkmcnt(3)
    v_mfma_f32_32x32x16_bf16 v[204:219], v[128:131], v[72:75], v[56:71]
    v_exp_f32 v193, v193
    v_exp_f32 v194, v194
    v_cvt_pk_bf16_f32 v189, v190, v191
    v_exp_f32 v195, v195
    s_waitcnt lgkmcnt(2)
    v_mfma_f32_32x32x16_bf16 v[204:219], v[132:135], v[30:33], v[204:219]
    v_cvt_pk_bf16_f32 v190, v192, v193
    ds_read_b64_tr_b16 v[140:141], v14 offset:3840
    ds_read_b64_tr_b16 v[142:143], v14 offset:4480
    v_cvt_pk_bf16_f32 v191, v194, v195
    v_exp_f32 v196, v196
    v_exp_f32 v197, v197
    s_waitcnt lgkmcnt(2)
    v_mfma_f32_32x32x16_bf16 v[156:171], v[136:139], v[188:191], v[156:171]
    buffer_load_dwordx2 v[116:117], v9, s[32:35], s50 offen offset:0 sc1
    buffer_load_dwordx2 v[118:119], v9, s[32:35], s50 offen offset:128 sc1
    buffer_load_dwordx4 v[100:103], v2, s[32:35], s50 offen offset:0 sc1
    v_exp_f32 v198, v198
    v_exp_f32 v199, v199
    v_cvt_pk_bf16_f32 v192, v196, v197
    buffer_load_dwordx4 v[104:107], v2, s[32:35], s50 offen offset:1024 sc1
    ds_read_b64_tr_b16 v[136:137], v14 offset:0
    ds_read_b64_tr_b16 v[138:139], v14 offset:640
    v_exp_f32 v200, v200
    v_exp_f32 v201, v201
    buffer_load_dwordx4 v[108:111], v2, s[32:35], s50 offen offset:2048 sc1
    v_cvt_pk_bf16_f32 v193, v198, v199
    v_exp_f32 v202, v202
    v_exp_f32 v203, v203
    buffer_load_dwordx4 v[112:115], v2, s[32:35], s50 offen offset:3072 sc1
    v_cvt_pk_bf16_f32 v194, v200, v201
    v_cvt_pk_bf16_f32 v195, v202, v203
    v_exp_f32 v204, v204
    v_exp_f32 v205, v205
    s_waitcnt lgkmcnt(2)
    v_mfma_f32_32x32x16_bf16 v[156:171], v[140:143], v[192:195], v[156:171]
    v_exp_f32 v206, v206
    v_exp_f32 v207, v207
    v_cvt_pk_bf16_f32 v204, v204, v205
    v_exp_f32 v208, v208
    v_exp_f32 v209, v209
    v_exp_f32 v210, v210
    v_cvt_pk_bf16_f32 v205, v206, v207
    v_exp_f32 v211, v211
    v_cvt_pk_bf16_f32 v206, v208, v209
    ds_read_b64_tr_b16 v[140:141], v14 offset:1280
    ds_read_b64_tr_b16 v[142:143], v14 offset:1920
    v_cvt_pk_bf16_f32 v207, v210, v211
    v_exp_f32 v212, v212
    v_exp_f32 v213, v213
    s_waitcnt lgkmcnt(2)
    v_mfma_f32_32x32x16_bf16 v[156:171], v[136:139], v[204:207], v[156:171]
    v_exp_f32 v214, v214
    v_exp_f32 v215, v215
    v_cvt_pk_bf16_f32 v208, v212, v213
    v_exp_f32 v216, v216
    v_exp_f32 v217, v217
    v_cvt_pk_bf16_f32 v209, v214, v215
    v_exp_f32 v218, v218
    v_exp_f32 v219, v219
    v_cvt_pk_bf16_f32 v210, v216, v217
    v_cvt_pk_bf16_f32 v211, v218, v219
    s_waitcnt lgkmcnt(0)
    s_nop 0
    v_mfma_f32_32x32x16_bf16 v[156:171], v[140:143], v[208:211], v[156:171]
    s_mov_b32 s59, 0x28000000
    s_nop 10
    v_subrev_u32 v236, 0x2b800000, v168
    v_cmp_le_u32 vcc, s59, v236
    s_cmp_eq_u32 s21, 0
    s_cbranch_scc0 ol_24
NOFB1:
    s_add_u32 s42, s42, 5120
    s_add_u32 s11, s11, 5120
    s_cmp_eq_u64 vcc, 0
    s_cbranch_scc0 ol_32
NOFB0:
    v_rcp_f32 v236, v168
    v_sub_f32 v237, 1.0, v96
    v_mul_f32 v236, v236, v237
    v_mul_f32 v156, v156, v236
    v_mul_f32 v157, v157, v236
    v_mul_f32 v158, v158, v236
    v_mul_f32 v159, v159, v236
    v_mul_f32 v160, v160, v236
    v_mul_f32 v161, v161, v236
    v_mul_f32 v162, v162, v236
    v_mul_f32 v163, v163, v236
    v_mul_f32 v166, v166, v236
    v_mul_f32 v167, v167, v236
    v_cvt_pk_bf16_f32 v168, v156, v157
    v_cvt_pk_bf16_f32 v169, v158, v159
    v_cvt_pk_bf16_f32 v170, v160, v161
    v_cvt_pk_bf16_f32 v171, v162, v163
    buffer_store_dwordx4 v[168:171], v0, s[32:35], s42 offen offset:0 sc1
    v_cvt_pk_bf16_f32 v145, v166, v167
    s_mov_b32 exec_hi, 0
    buffer_store_dwordx2 v[144:145], v8, s[32:35], s11 offen sc1
    s_mov_b32 exec_hi, -1
    s_waitcnt vmcnt(15)
    v_max3_u32 v120, v220, v221, v220
    v_max3_u32 v121, v222, v223, v222
    s_waitcnt vmcnt(13)
    v_max3_u32 v120, v224, v225, v120
    v_max3_u32 v121, v226, v227, v121
    s_waitcnt vmcnt(11)
    v_max3_u32 v120, v228, v229, v120
    v_max3_u32 v121, v230, v231, v121
    s_waitcnt vmcnt(9)
    v_max3_u32 v120, v232, v233, v120
    v_max3_u32 v121, v234, v235, v121
    v_max_u32 v120, v120, v121
    v_cmp_eq_u32 vcc, -1, v120
    s_cmp_eq_u64 vcc, 0
    s_cbranch_scc0 ol_35
dd_34:
    v_mfma_f32_16x16x32_bf16 v[22:25], a[32:35], v[220:223], 0
    s_lshl_b32 s58, s52, 13
    v_add_u32 v12, s58, v2
    v_mfma_f32_16x16x32_bf16 v[26:29], a[36:39], v[220:223], 0
    v_xor_b32 v13, 8192, v12
    v_xor_b32 v14, 16384, v12
    s_add_u32 s20, s2, 65536
    buffer_load_dwordx4 v[132:135], v2, s[32:35], s20 offen offset:1024 sc1
    v_mfma_f32_16x16x32_bf16 v[40:43], a[40:43], v[220:223], 0
    v_xor_b32 v15, 24576, v12
    v_lshrrev_b32 v16, 4, v1
    v_mfma_f32_16x16x32_bf16 v[44:47], a[40:43], v[224:227], 0
    v_and_b32 v17, 15, v1
    v_mul_u32_u24 v17, 1152, v17
    v_mfma_f32_16x16x32_bf16 v[48:51], a[44:47], v[220:223], 0
    v_lshl_add_u32 v19, v16, 3, v17
    v_lshl_add_u32 v16, v16, 4, v17
    buffer_load_dwordx4 v[136:139], v2, s[32:35], s20 offen offset:2048 sc1
    v_mfma_f32_16x16x32_bf16 v[52:55], a[44:47], v[224:227], 0
    s_lshl_b32 s58, s52, 6
    v_add_u32 v16, s58, v16
    v_mfma_f32_16x16x32_bf16 v[80:83], a[48:51], v[220:223], 0
    v_mfma_f32_16x16x32_bf16 v[84:87], a[48:51], v[224:227], 0
    buffer_load_dwordx4 v[140:143], v2, s[32:35], s20 offen offset:3072 sc1
    v_add_u32 v12, 98304, v12
    v_mfma_f32_16x16x32_bf16 v[88:91], a[52:55], v[220:223], 0
    v_add_u32 v13, 98304, v13
    v_mfma_f32_16x16x32_bf16 v[92:95], a[52:55], v[224:227], 0
    v_add_u32 v14, 98304, v14
    v_mfma_f32_16x16x32_bf16 v[148:151], a[56:59], v[220:223], 0
    s_add_u32 s20, s2, 73728
    buffer_load_dwordx4 v[212:215], v2, s[32:35], s20 offen offset:2048 sc1
    v_add_u32 v15, 98304, v15
    v_mfma_f32_16x16x32_bf16 v[152:155], a[56:59], v[224:227], 0
    s_lshl_b32 s59, s52, 4
    v_mfma_f32_16x16x32_bf16 v[172:175], a[60:63], v[220:223], 0
    v_mfma_f32_16x16x32_bf16 v[176:179], a[60:63], v[224:227], 0
    buffer_load_dwordx4 v[216:219], v2, s[32:35], s20 offen offset:3072 sc1
    v_mfma_f32_16x16x32_bf16 v[180:183], a[64:67], v[220:223], 0
    v_mfma_f32_16x16x32_bf16 v[184:187], a[64:67], v[224:227], 0
    v_mfma_f32_16x16x32_bf16 v[22:25], a[68:71], v[228:231], v[22:25]
    s_add_u32 s20, s2, 77824
    buffer_load_dwordx4 v[56:59], v2, s[32:35], s20 offen offset:0 sc1
    v_mfma_f32_16x16x32_bf16 v[26:29], a[72:75], v[228:231], v[26:29]
    v_mfma_f32_16x16x32_bf16 v[40:43], a[76:79], v[228:231], v[40:43]
    v_mfma_f32_16x16x32_bf16 v[44:47], a[76:79], v[232:235], v[44:47]
    s_add_u32 s20, s2, 69632
    buffer_load_dwordx4 v[188:191], v2, s[32:35], s20 offen offset:0 sc1
    v_mfma_f32_16x16x32_bf16 v[48:51], a[80:83], v[228:231], v[48:51]
    v_max3_u32 v120, v240, v241, v240
    v_mfma_f32_16x16x32_bf16 v[52:55], a[80:83], v[232:235], v[52:55]
    v_max3_u32 v121, v242, v243, v242
    v_mfma_f32_16x16x32_bf16 v[80:83], a[84:87], v[228:231], v[80:83]
    buffer_load_dwordx4 v[192:195], v2, s[32:35], s20 offen offset:1024 sc1
    v_max3_u32 v120, v244, v245, v120
    v_mfma_f32_16x16x32_bf16 v[84:87], a[84:87], v[232:235], v[84:87]
    v_max3_u32 v121, v246, v247, v121
    v_mfma_f32_16x16x32_bf16 v[88:91], a[88:91], v[228:231], v[88:91]
    v_max3_u32 v120, v248, v249, v120
    v_mfma_f32_16x16x32_bf16 v[92:95], a[88:91], v[232:235], v[92:95]
    buffer_load_dwordx4 v[196:199], v2, s[32:35], s20 offen offset:2048 sc1
    v_max3_u32 v121, v250, v251, v121
    v_mfma_f32_16x16x32_bf16 v[148:151], a[92:95], v[228:231], v[148:151]
    s_waitcnt vmcnt(17)
    v_max3_u32 v120, v252, v253, v120
    v_mfma_f32_16x16x32_bf16 v[152:155], a[92:95], v[232:235], v[152:155]
    v_max3_u32 v121, v254, v255, v121
    v_mfma_f32_16x16x32_bf16 v[172:175], a[96:99], v[228:231], v[172:175]
    buffer_load_dwordx4 v[200:203], v2, s[32:35], s20 offen offset:3072 sc1
    v_max_u32 v120, v120, v121
    v_mfma_f32_16x16x32_bf16 v[176:179], a[96:99], v[232:235], v[176:179]
    v_cmp_eq_u32 vcc, -1, v120
    v_mfma_f32_16x16x32_bf16 v[180:183], a[100:103], v[228:231], v[180:183]
    s_cmp_eq_u64 vcc, 0
    s_cbranch_scc0 ol_38
dd_37:
    v_mfma_f32_16x16x32_bf16 v[184:187], a[100:103], v[232:235], v[184:187]
    s_add_u32 s20, s2, 77824
    buffer_load_dwordx4 v[60:63], v2, s[32:35], s20 offen offset:1024 sc1
    v_mfma_f32_16x16x32_bf16 v[22:25], a[104:107], v[240:243], v[22:25]
    v_mfma_f32_16x16x32_bf16 v[26:29], a[108:111], v[240:243], v[26:29]
    v_mfma_f32_16x16x32_bf16 v[40:43], a[112:115], v[240:243], v[40:43]
    buffer_load_dwordx4 v[64:67], v2, s[32:35], s20 offen offset:2048 sc1
    v_mfma_f32_16x16x32_bf16 v[44:47], a[112:115], v[244:247], v[44:47]
    v_mfma_f32_16x16x32_bf16 v[48:51], a[116:119], v[240:243], v[48:51]
    v_mfma_f32_16x16x32_bf16 v[52:55], a[116:119], v[244:247], v[52:55]
    buffer_load_dwordx4 v[68:71], v2, s[32:35], s20 offen offset:3072 sc1
    v_mfma_f32_16x16x32_bf16 v[80:83], a[120:123], v[240:243], v[80:83]
    v_mfma_f32_16x16x32_bf16 v[84:87], a[120:123], v[244:247], v[84:87]
    v_mfma_f32_16x16x32_bf16 v[88:91], a[124:127], v[240:243], v[88:91]
    s_add_u32 s20, s2, 81920
    buffer_load_dwordx4 v[72:75], v2, s[32:35], s20 offen offset:0 sc1
    v_mfma_f32_16x16x32_bf16 v[92:95], a[124:127], v[244:247], v[92:95]
    v_mfma_f32_16x16x32_bf16 v[148:151], a[128:131], v[240:243], v[148:151]
    v_mfma_f32_16x16x32_bf16 v[152:155], a[128:131], v[244:247], v[152:155]
    s_add_u32 s20, s2, 65536
    buffer_load_dwordx4 v[128:131], v2, s[32:35], s20 offen offset:0 sc1
    v_mfma_f32_16x16x32_bf16 v[172:175], a[132:135], v[240:243], v[172:175]
    v_mfma_f32_16x16x32_bf16 v[176:179], a[132:135], v[244:247], v[176:179]
    v_mfma_f32_16x16x32_bf16 v[180:183], a[136:139], v[240:243], v[180:183]
    s_add_u32 s20, s2, 73728
    buffer_load_dwordx4 v[204:207], v2, s[32:35], s20 offen offset:0 sc1
    v_mfma_f32_16x16x32_bf16 v[184:187], a[136:139], v[244:247], v[184:187]
    v_mfma_f32_16x16x32_bf16 v[22:25], a[140:143], v[248:251], v[22:25]
    v_mfma_f32_16x16x32_bf16 v[26:29], a[144:147], v[248:251], v[26:29]
    buffer_load_dwordx4 v[208:211], v2, s[32:35], s20 offen offset:1024 sc1
    v_mfma_f32_16x16x32_bf16 v[40:43], a[148:151], v[248:251], v[40:43]
    s_waitcnt vmcnt(22)
    v_max3_u32 v120, v100, v101, v100
    v_mfma_f32_16x16x32_bf16 v[44:47], a[148:151], v[252:255], v[44:47]
    v_max3_u32 v121, v102, v103, v102
    v_mfma_f32_16x16x32_bf16 v[48:51], a[152:155], v[248:251], v[48:51]
    s_waitcnt vmcnt(21)
    v_max3_u32 v120, v104, v105, v120
    v_mfma_f32_16x16x32_bf16 v[52:55], a[152:155], v[252:255], v[52:55]
    v_max3_u32 v121, v106, v107, v121
    v_mfma_f32_16x16x32_bf16 v[80:83], a[156:159], v[248:251], v[80:83]
    s_waitcnt vmcnt(20)
    v_max3_u32 v120, v108, v109, v120
    v_mfma_f32_16x16x32_bf16 v[84:87], a[156:159], v[252:255], v[84:87]
    v_max3_u32 v121, v110, v111, v121
    v_mfma_f32_16x16x32_bf16 v[88:91], a[160:163], v[248:251], v[88:91]
    s_waitcnt vmcnt(19)
    v_max3_u32 v120, v112, v113, v120
    v_mfma_f32_16x16x32_bf16 v[92:95], a[160:163], v[252:255], v[92:95]
    v_max3_u32 v121, v114, v115, v121
    v_mfma_f32_16x16x32_bf16 v[148:151], a[164:167], v[248:251], v[148:151]
    v_max3_u32 v120, v116, v117, v120
    v_mfma_f32_16x16x32_bf16 v[152:155], a[164:167], v[252:255], v[152:155]
    v_max3_u32 v121, v118, v119, v121
    v_mfma_f32_16x16x32_bf16 v[172:175], a[168:171], v[248:251], v[172:175]
    v_max_u32 v120, v120, v121
    buffer_load_dwordx4 v[156:159], v2, s[32:35], s51 offen offset:0 sc1
    v_mfma_f32_16x16x32_bf16 v[176:179], a[168:171], v[252:255], v[176:179]
    v_cmp_eq_u32 vcc, -1, v120
    v_mfma_f32_16x16x32_bf16 v[180:183], a[172:175], v[248:251], v[180:183]
    s_cmp_eq_u64 vcc, 0
    s_cbranch_scc0 ol_41
dd_40:
    v_mfma_f32_16x16x32_bf16 v[184:187], a[172:175], v[252:255], v[184:187]
    v_mfma_f32_16x16x32_bf16 v[22:25], a[176:179], v[100:103], v[22:25]
    buffer_load_dwordx4 v[160:163], v2, s[32:35], s51 offen offset:1024 sc1
    v_mfma_f32_16x16x32_bf16 v[26:29], a[180:183], v[100:103], v[26:29]
    v_mfma_f32_16x16x32_bf16 v[40:43], a[184:187], v[100:103], v[40:43]
    v_mfma_f32_16x16x32_bf16 v[48:51], a[188:191], v[100:103], v[48:51]
    v_mfma_f32_16x16x32_bf16 v[80:83], a[192:195], v[100:103], v[80:83]
    buffer_load_dwordx4 v[164:167], v2, s[32:35], s51 offen offset:2048 sc1
    v_mfma_f32_16x16x32_bf16 v[88:91], a[196:199], v[100:103], v[88:91]
    v_mfma_f32_16x16x32_bf16 v[148:151], a[200:203], v[100:103], v[148:151]
    v_mfma_f32_16x16x32_bf16 v[172:175], a[204:207], v[100:103], v[172:175]
    v_mfma_f32_16x16x32_bf16 v[180:183], a[208:211], v[100:103], v[180:183]
    buffer_load_dwordx4 v[168:171], v2, s[32:35], s51 offen offset:3072 sc1
    v_mfma_f32_16x16x32_bf16 v[22:25], a[212:215], v[104:107], v[22:25]
    v_mfma_f32_16x16x32_bf16 v[26:29], a[216:219], v[104:107], v[26:29]
    v_mfma_f32_16x16x32_bf16 v[40:43], a[220:223], v[104:107], v[40:43]
    v_mfma_f32_16x16x32_bf16 v[48:51], a[224:227], v[104:107], v[48:51]
    buffer_load_dwordx2 v[124:125], v9, s[32:35], s51 offen offset:0 sc1
    v_mfma_f32_16x16x32_bf16 v[80:83], a[228:231], v[104:107], v[80:83]
    v_mfma_f32_16x16x32_bf16 v[88:91], a[232:235], v[104:107], v[88:91]
    v_mfma_f32_16x16x32_bf16 v[148:151], a[236:239], v[104:107], v[148:151]
    v_mfma_f32_16x16x32_bf16 v[172:175], a[240:243], v[104:107], v[172:175]
    buffer_load_dwordx2 v[126:127], v9, s[32:35], s51 offen offset:128 sc1
    v_mfma_f32_16x16x32_bf16 v[180:183], a[244:247], v[104:107], v[180:183]
    v_mfma_f32_16x16x32_bf16 v[22:25], a[248:251], v[108:111], v[22:25]
    v_mfma_f32_16x16x32_bf16 v[26:29], a[252:255], v[108:111], v[26:29]
    v_mfma_f32_16x16x32_bf16 v[40:43], a[0:3], v[108:111], v[40:43]
    v_mfma_f32_16x16x32_bf16 v[48:51], a[4:7], v[108:111], v[48:51]
    v_mfma_f32_16x16x32_bf16 v[80:83], a[8:11], v[108:111], v[80:83]
    v_mfma_f32_16x16x32_bf16 v[88:91], a[12:15], v[108:111], v[88:91]
    v_mfma_f32_16x16x32_bf16 v[148:151], a[16:19], v[108:111], v[148:151]
    v_mfma_f32_16x16x32_bf16 v[172:175], a[20:23], v[108:111], v[172:175]
    v_mfma_f32_16x16x32_bf16 v[180:183], a[24:27], v[108:111], v[180:183]
    s_waitcnt vmcnt(22)
    v_mfma_f32_16x16x32_bf16 v[40:43], v[132:135], v[112:115], v[40:43]
    s_waitcnt vmcnt(21)
    v_mfma_f32_16x16x32_bf16 v[48:51], v[136:139], v[112:115], v[48:51]
    s_waitcnt vmcnt(20)
    v_mfma_f32_16x16x32_bf16 v[80:83], v[140:143], v[112:115], v[80:83]
    s_waitcnt vmcnt(19)
    v_mfma_f32_16x16x32_bf16 v[40:43], v[212:215], v[116:119], v[40:43]
    s_waitcnt vmcnt(18)
    v_mfma_f32_16x16x32_bf16 v[48:51], v[216:219], v[116:119], v[48:51]
    s_waitcnt vmcnt(17)
    v_mfma_f32_16x16x32_bf16 v[80:83], v[56:59], v[116:119], v[80:83]
    s_waitcnt vmcnt(16)
    v_mfma_f32_16x16x32_bf16 v[88:91], v[188:191], v[112:115], v[88:91]
    s_waitcnt vmcnt(15)
    v_mfma_f32_16x16x32_bf16 v[148:151], v[192:195], v[112:115], v[148:151]
    s_waitcnt vmcnt(14)
    v_mfma_f32_16x16x32_bf16 v[172:175], v[196:199], v[112:115], v[172:175]
    ds_write_b128 v13, v[40:43] offset:2048
    s_waitcnt vmcnt(13)
    v_mfma_f32_16x16x32_bf16 v[180:183], v[200:203], v[112:115], v[180:183]
    s_waitcnt vmcnt(12)
    v_mfma_f32_16x16x32_bf16 v[88:91], v[60:63], v[116:119], v[88:91]
    ds_write_b128 v13, v[48:51] offset:3072
    s_waitcnt vmcnt(11)
    v_mfma_f32_16x16x32_bf16 v[148:151], v[64:67], v[116:119], v[148:151]
    s_waitcnt vmcnt(5)
    v_max3_u32 v120, v156, v157, v156
    v_max3_u32 v121, v158, v159, v158
    v_mfma_f32_16x16x32_bf16 v[172:175], v[68:71], v[116:119], v[172:175]
    s_waitcnt vmcnt(4)
    v_max3_u32 v120, v160, v161, v120
    v_max3_u32 v121, v162, v163, v121
    ds_write_b128 v14, v[80:83] offset:4096
    v_mfma_f32_16x16x32_bf16 v[180:183], v[72:75], v[116:119], v[180:183]
    s_waitcnt vmcnt(3)
    v_max3_u32 v120, v164, v165, v120
    v_max3_u32 v121, v166, v167, v121
    v_mfma_f32_16x16x32_bf16 v[22:25], a[28:31], v[112:115], v[22:25]
    s_waitcnt vmcnt(2)
    v_max3_u32 v120, v168, v169, v120
    v_max3_u32 v121, v170, v171, v121
    v_mfma_f32_16x16x32_bf16 v[26:29], v[128:131], v[112:115], v[26:29]
    s_waitcnt vmcnt(1)
    v_max3_u32 v120, v124, v125, v120
    s_waitcnt vmcnt(0)
    v_max3_u32 v121, v126, v127, v121
    ds_write_b128 v14, v[88:91] offset:5120
    v_mfma_f32_16x16x32_bf16 v[22:25], v[204:207], v[116:119], v[22:25]
    v_max_u32 v120, v120, v121
    v_cmp_eq_u32 vcc, -1, v120
    v_mfma_f32_16x16x32_bf16 v[26:29], v[208:211], v[116:119], v[26:29]
    s_cmp_eq_u64 vcc, 0
    s_cbranch_scc0 ol_44
dd_43:
    ds_write_b128 v15, v[148:151] offset:6144
    v_mfma_f32_16x16x32_bf16 v[44:47], a[184:187], v[156:159], v[44:47]
    v_mfma_f32_16x16x32_bf16 v[52:55], a[188:191], v[156:159], v[52:55]
    ds_write_b128 v15, v[172:175] offset:7168
    v_mfma_f32_16x16x32_bf16 v[84:87], a[192:195], v[156:159], v[84:87]
    v_mfma_f32_16x16x32_bf16 v[44:47], a[220:223], v[160:163], v[44:47]
    ds_write_b128 v12, v[180:183] offset:0
    v_mfma_f32_16x16x32_bf16 v[52:55], a[224:227], v[160:163], v[52:55]
    v_mfma_f32_16x16x32_bf16 v[84:87], a[228:231], v[160:163], v[84:87]
    s_waitcnt lgkmcnt(0)
    s_barrier
    ds_read_b128 v[220:223], v12 offset:2048
    v_mfma_f32_16x16x32_bf16 v[44:47], a[0:3], v[164:167], v[44:47]
    ds_read_b128 v[228:231], v12 offset:3072
    v_mfma_f32_16x16x32_bf16 v[52:55], a[4:7], v[164:167], v[52:55]
    v_mfma_f32_16x16x32_bf16 v[84:87], a[8:11], v[164:167], v[84:87]
    ds_read_b128 v[240:243], v12 offset:4096
    v_mfma_f32_16x16x32_bf16 v[44:47], v[132:135], v[168:171], v[44:47]
    ds_read_b128 v[248:251], v12 offset:5120
    v_mfma_f32_16x16x32_bf16 v[52:55], v[136:139], v[168:171], v[52:55]
    v_mfma_f32_16x16x32_bf16 v[84:87], v[140:143], v[168:171], v[84:87]
    ds_read_b128 v[112:115], v12 offset:6144
    v_mfma_f32_16x16x32_bf16 v[44:47], v[212:215], v[124:127], v[44:47]
    ds_read_b128 v[116:119], v12 offset:7168
    v_mfma_f32_16x16x32_bf16 v[52:55], v[216:219], v[124:127], v[52:55]
    v_mfma_f32_16x16x32_bf16 v[84:87], v[56:59], v[124:127], v[84:87]
    ds_read_b128 v[100:103], v13 offset:0
    v_mfma_f32_16x16x32_bf16 v[92:95], a[196:199], v[156:159], v[92:95]
    ds_read_b128 v[104:107], v14 offset:0
    v_mfma_f32_16x16x32_bf16 v[152:155], a[200:203], v[156:159], v[152:155]
    v_mfma_f32_16x16x32_bf16 v[176:179], a[204:207], v[156:159], v[176:179]
    ds_read_b128 v[108:111], v15 offset:0
    ds_write_b128 v13, v[44:47] offset:34816
    v_mfma_f32_16x16x32_bf16 v[184:187], a[208:211], v[156:159], v[184:187]
    s_waitcnt lgkmcnt(7)
    v_add_f32 v240, v240, v220
    v_add_f32 v241, v241, v221
    v_add_f32 v242, v242, v222
    v_mfma_f32_16x16x32_bf16 v[92:95], a[232:235], v[160:163], v[92:95]
    v_add_f32 v243, v243, v223
    s_waitcnt lgkmcnt(6)
    v_add_f32 v248, v248, v228
    ds_write_b128 v13, v[52:55] offset:35840
    v_mfma_f32_16x16x32_bf16 v[152:155], a[236:239], v[160:163], v[152:155]
    v_add_f32 v249, v249, v229
    v_add_f32 v250, v250, v230
    v_mfma_f32_16x16x32_bf16 v[176:179], a[240:243], v[160:163], v[176:179]
    v_add_f32 v251, v251, v231
    s_waitcnt lgkmcnt(6)
    v_add_f32 v240, v240, v112
    ds_write_b128 v14, v[84:87] offset:36864
    v_mfma_f32_16x16x32_bf16 v[184:187], a[244:247], v[160:163], v[184:187]
    v_add_f32 v241, v241, v113
    v_add_f32 v242, v242, v114
    v_add_f32 v243, v243, v115
    v_mfma_f32_16x16x32_bf16 v[92:95], a[12:15], v[164:167], v[92:95]
    s_waitcnt lgkmcnt(6)
    v_add_f32 v248, v248, v116
    v_add_f32 v249, v249, v117
    v_mfma_f32_16x16x32_bf16 v[152:155], a[16:19], v[164:167], v[152:155]
    v_add_f32 v250, v250, v118
    v_add_f32 v251, v251, v119
    v_mfma_f32_16x16x32_bf16 v[176:179], a[20:23], v[164:167], v[176:179]
    v_add_f32 v22, v22, v240
    v_add_f32 v23, v23, v241
    v_mfma_f32_16x16x32_bf16 v[184:187], a[24:27], v[164:167], v[184:187]
    v_add_f32 v24, v24, v242
    v_add_f32 v25, v25, v243
    v_mfma_f32_16x16x32_bf16 v[92:95], v[188:191], v[168:171], v[92:95]
    v_add_f32 v26, v26, v248
    v_add_f32 v27, v27, v249
    v_add_f32 v28, v28, v250
    v_mfma_f32_16x16x32_bf16 v[152:155], v[192:195], v[168:171], v[152:155]
    v_add_f32 v29, v29, v251
    v_cvt_pk_bf16_f32 v220, v22, v23
    v_mfma_f32_16x16x32_bf16 v[176:179], v[196:199], v[168:171], v[176:179]
    v_cvt_pk_bf16_f32 v221, v24, v25
    v_cvt_pk_bf16_f32 v222, v26, v27
    v_mfma_f32_16x16x32_bf16 v[184:187], v[200:203], v[168:171], v[184:187]
    v_cvt_pk_bf16_f32 v223, v28, v29
    buffer_store_dwordx4 v[220:223], v16, s[44:47], s0 offen
    v_mfma_f32_16x16x32_bf16 v[92:95], v[60:63], v[124:127], v[92:95]
    s_waitcnt lgkmcnt(5)
    v_add_f32 v180, v180, v100
    v_add_f32 v181, v181, v101
    v_add_f32 v182, v182, v102
    v_mfma_f32_16x16x32_bf16 v[152:155], v[64:67], v[124:127], v[152:155]
    v_add_f32 v183, v183, v103
    s_waitcnt lgkmcnt(3)
    v_add_f32 v104, v104, v108
    v_mfma_f32_16x16x32_bf16 v[176:179], v[68:71], v[124:127], v[176:179]
    v_add_f32 v105, v105, v109
    v_add_f32 v106, v106, v110
    v_mfma_f32_16x16x32_bf16 v[184:187], v[72:75], v[124:127], v[184:187]
    v_add_f32 v107, v107, v111
    v_add_f32 v180, v180, v104
    v_mfma_f32_16x16x32_bf16 v[76:79], a[32:35], v[224:227], 0
    v_add_f32 v181, v181, v105
    v_add_f32 v182, v182, v106
    v_mfma_f32_16x16x32_bf16 v[144:147], a[36:39], v[224:227], 0
    v_add_f32 v183, v183, v107
    v_cvt_pk_bf16_f32 v180, v180, v181
    v_cvt_pk_bf16_f32 v181, v182, v183
    ds_write_b128 v14, v[92:95] offset:37888
    v_mfma_f32_16x16x32_bf16 v[76:79], a[68:71], v[232:235], v[76:79]
    s_lshl_b64 exec, 0xffff, s59
    buffer_store_dwordx2 v[180:181], v19, s[44:47], s0 offen offset:256
    s_mov_b64 exec, -1
    v_mfma_f32_16x16x32_bf16 v[144:147], a[72:75], v[232:235], v[144:147]
    ds_write_b128 v15, v[152:155] offset:38912
    v_mfma_f32_16x16x32_bf16 v[76:79], a[104:107], v[244:247], v[76:79]
    v_mfma_f32_16x16x32_bf16 v[144:147], a[108:111], v[244:247], v[144:147]
    ds_write_b128 v15, v[176:179] offset:39936
    v_mfma_f32_16x16x32_bf16 v[76:79], a[140:143], v[252:255], v[76:79]
    v_mfma_f32_16x16x32_bf16 v[144:147], a[144:147], v[252:255], v[144:147]
    ds_write_b128 v12, v[184:187] offset:32768
    v_mfma_f32_16x16x32_bf16 v[76:79], a[176:179], v[156:159], v[76:79]
    v_mfma_f32_16x16x32_bf16 v[144:147], a[180:183], v[156:159], v[144:147]
    s_waitcnt lgkmcnt(0)
    s_barrier
    ds_read_b128 v[100:103], v13 offset:32768
    v_mfma_f32_16x16x32_bf16 v[76:79], a[212:215], v[160:163], v[76:79]
    ds_read_b128 v[104:107], v14 offset:32768
    v_mfma_f32_16x16x32_bf16 v[144:147], a[216:219], v[160:163], v[144:147]
    ds_read_b128 v[108:111], v15 offset:32768
    v_mfma_f32_16x16x32_bf16 v[76:79], a[248:251], v[164:167], v[76:79]
    ds_read_b128 v[40:43], v12 offset:34816
    v_mfma_f32_16x16x32_bf16 v[144:147], a[252:255], v[164:167], v[144:147]
    ds_read_b128 v[48:51], v12 offset:35840
    v_mfma_f32_16x16x32_bf16 v[76:79], a[28:31], v[168:171], v[76:79]
    ds_read_b128 v[80:83], v12 offset:36864
    v_mfma_f32_16x16x32_bf16 v[144:147], v[128:131], v[168:171], v[144:147]
    ds_read_b128 v[88:91], v12 offset:37888
    v_mfma_f32_16x16x32_bf16 v[76:79], v[204:207], v[124:127], v[76:79]
    ds_read_b128 v[148:151], v12 offset:38912
    v_mfma_f32_16x16x32_bf16 v[144:147], v[208:211], v[124:127], v[144:147]
    ds_read_b128 v[172:175], v12 offset:39936
    s_waitcnt lgkmcnt(8)
    v_pk_add_f32 v[184:185], v[184:185], v[100:101]
    v_pk_add_f32 v[186:187], v[186:187], v[102:103]
    s_waitcnt lgkmcnt(6)
    v_pk_add_f32 v[104:105], v[104:105], v[108:109]
    v_pk_add_f32 v[106:107], v[106:107], v[110:111]
    v_pk_add_f32 v[184:185], v[184:185], v[104:105]
    v_pk_add_f32 v[186:187], v[186:187], v[106:107]
    v_cvt_pk_bf16_f32 v184, v184, v185
    v_cvt_pk_bf16_f32 v185, v186, v187
    s_lshl_b64 exec, 0xffff, s59
    buffer_store_dwordx2 v[184:185], v19, s[44:47], s10 offen offset:256
    s_mov_b64 exec, -1
    s_waitcnt lgkmcnt(3)
    v_pk_add_f32 v[80:81], v[80:81], v[40:41]
    v_pk_add_f32 v[82:83], v[82:83], v[42:43]
    s_waitcnt lgkmcnt(2)
    v_pk_add_f32 v[88:89], v[88:89], v[48:49]
    v_pk_add_f32 v[90:91], v[90:91], v[50:51]
    s_waitcnt lgkmcnt(1)
    v_pk_add_f32 v[80:81], v[80:81], v[148:149]
    v_pk_add_f32 v[82:83], v[82:83], v[150:151]
    s_waitcnt lgkmcnt(0)
    v_pk_add_f32 v[88:89], v[88:89], v[172:173]
    v_pk_add_f32 v[90:91], v[90:91], v[174:175]
    v_pk_add_f32 v[76:77], v[76:77], v[80:81]
    v_pk_add_f32 v[78:79], v[78:79], v[82:83]
    v_pk_add_f32 v[144:145], v[144:145], v[88:89]
    v_pk_add_f32 v[146:147], v[146:147], v[90:91]
    v_cvt_pk_bf16_f32 v40, v76, v77
    v_cvt_pk_bf16_f32 v41, v78, v79
    v_cvt_pk_bf16_f32 v42, v144, v145
    v_cvt_pk_bf16_f32 v43, v146, v147
    buffer_store_dwordx4 v[40:43], v16, s[44:47], s10 offen
    s_or_b32 s58, s3, s52
    s_cmp_lg_u32 s58, 0
    s_cbranch_scc0 ol_45
NOEP:
    s_waitcnt vmcnt(0)
END:
    s_endpgm
P0B:
    s_getpc_b64 s[44:45]
pc_1:
    s_sub_u32 s44, s44, pc_1-P0A
    s_subb_u32 s45, s45, 0
    s_mov_b32 s46, CEND-P0A
    s_mov_b32 s47, 0x00020000
    v_lshlrev_b32 v60, 7, v0
    buffer_load_dword v61, v60, s[44:47], 0 offen
    s_and_b32 s58, s2, 3
    s_lshl_b32 s58, s58, 1
    s_bfe_u32 s59, s2, 0x10003
    s_add_u32 s54, s58, s59
    s_lshr_b32 s55, s2, 5
    s_and_b32 s58, s2, 4
    s_lshl_b32 s58, s58, 2
    s_lshr_b32 s59, s2, 4
    s_add_u32 s53, s58, s59
    s_lshl_b32 s50, s55, 7
    s_mul_i32 s101, s52, 24576
    v_lshrrev_b32 v12, 3, v1
    v_mul_u32_u24 v12, 1152, v12
    v_lshrrev_b32 v13, 4, v1
    v_and_b32 v14, 7, v1
    v_xor_b32 v14, v13, v14
    v_lshl_add_u32 v4, v14, 4, v12
    v_xor_b32 v14, 4, v14
    v_lshl_add_u32 v5, v14, 4, v12
    v_add_u32 v5, 8192, v5
    v_add_u32 v6, 16384, v4
    v_add_u32 v7, 16384, v5
    s_lshl_b32 s58, s54, 3
    s_add_u32 s59, s58, s52
    s_mul_i32 s48, s59, 36864
    s_sub_u32 s59, s58, s52
    s_add_u32 s59, s59, 7
    s_mul_i32 s49, s59, 36864
    s_mov_b32 s28, s4
    s_mov_b32 s29, s5
    s_mov_b32 s30, 2359296
    s_mov_b32 s31, 0x00020000
    v_and_b32 v12, 15, v1
    v_lshrrev_b32 v13, 4, v1
    v_lshrrev_b32 v14, 1, v12
    v_xor_b32 v14, v13, v14
    v_lshlrev_b32 v12, 7, v12
    v_lshl_add_u32 v12, v14, 4, v12
    v_add_u32 v8, s101, v12
    v_xor_b32 v9, 64, v8
    s_mul_i32 s58, s53, 648
    s_add_u32 s44, s8, s58
    s_addc_u32 s45, s9, 0
    s_mov_b32 s46, 648
    s_mov_b32 s47, 0x00020000
    s_lshl_b32 s58, s52, 8
    v_lshlrev_b32 v12, 2, v0
    s_add_u32 m0, s58, 162816
    s_nop 0
    buffer_load_dword v12, s[44:47], 0 offen lds
    s_waitcnt lgkmcnt(0)
    s_add_u32 s56, s56, 0x9e3779b9
    s_addc_u32 s57, s57, 0x7f4a7c15
    v_accvgpr_write_b32 a254, s56
    v_accvgpr_write_b32 a255, s57
    s_sub_u32 s98, 255, s3
    s_lshr_b32 s4, s98, 2
    s_and_b32 s5, s98, 3
    s_sub_u32 s8, s98, 144
    s_lshl_b32 s6, s52, 6
    s_cmp_lt_u32 s98, 144
    s_cselect_b32 s4, s4, s8
    s_cselect_b32 s5, s5, s52
    s_cselect_b32 s6, s6, 256
    s_cselect_b32 s7, 16, 8
    s_cselect_b32 s8, 0, 268435456
    v_add_u32 v51, s8, v2
    s_cmp_lt_u32 s98, 180
    s_cselect_b32 s8, 0, 268435456
    s_cselect_b32 s38, 663552, 0
    s_mov_b32 s39, 0x00020000
    s_mov_b32 s42, s38
    s_mov_b32 s43, 0x00020000
    v_add_u32 v50, s8, v2
    s_bfe_u32 s8, s4, 0x20002
    s_and_b32 s9, s4, 3
    s_lshr_b32 s13, s4, 4
    s_lshl_b32 s16, s13, 2
    s_add_u32 s16, s16, s9
    s_and_b32 s17, s4, 15
    s_mul_i32 s17, s17, 36
    s_mul_i32 s20, s9, 144
    s_add_u32 s20, s20, 16
    s_cmp_lt_u32 s4, 32
    s_cselect_b32 s8, s8, s9
    s_cselect_b32 s16, s16, 8
    s_cselect_b32 s17, s17, s20
    s_cselect_b32 s21, 23040, 0
    s_cselect_b32 s96, 4, 36
    s_cselect_b32 s97, 8, 2
    s_cselect_b64 vcc, -1, 0
    s_cmp_lt_u32 s4, 16
    s_cselect_b32 s40, s10, s14
    s_cselect_b32 s41, s11, s15
    s_cmp_eq_u32 s13, 1
    s_cselect_b32 s36, s14, s10
    s_cselect_b32 s37, s15, s11
    s_mul_i32 s17, s17, 1152
    s_mul_i32 s20, s5, 288
    s_add_u32 s17, s17, s20
    s_add_u32 s17, s17, s6
    s_add_u32 s21, s21, s17
    s_xor_b32 s12, s8, s52
    s_cmp_lt_u32 s98, 144
    s_cselect_b32 s12, s12, 4
    s_mul_i32 s9, s16, 9
    s_mul_i32 s16, s16, 5
    s_add_u32 s16, s16, s12
    s_lshl_b32 s12, s12, 1
    s_add_u32 s12, s12, s9
    s_lshl_b32 s5, s5, 2
    s_add_u32 s5, s5, s8
    s_mul_i32 s8, s5, 81
    s_add_u32 s8, s8, s12
    s_lshl_b32 s8, s8, 10
    s_add_u32 s0, s8, 4194304
    s_lshl_b32 s5, s5, 6
    s_add_u32 s5, s5, s16
    s_lshl_b32 s5, s5, 3
    s_add_u32 s1, s5, 40960
    s_lshl_b32 s20, s52, 11
    s_add_u32 s20, s20, 147456
    s_lshl_b32 s97, s97, 6
    v_lshrrev_b32 v44, 4, v1
    v_bfe_u32 v45, v1, 2, 2
    v_lshrrev_b32 v46, 1, v44
    v_lshl_add_u32 v46, v46, 4, v45
    v_and_b32 v47, 1, v44
    v_lshl_add_u32 v46, v47, 2, v46
    v_lshrrev_b32 v47, 1, v45
    v_lshl_add_u32 v47, v47, 2, v44
    v_and_b32 v48, 1, v45
    v_lshl_add_u32 v47, v47, 2, v48
    v_cndmask_b32 v46, v47, v46, vcc
    v_lshl_add_u32 v46, v46, 6, s20
    v_and_b32 v47, 3, v1
    v_mad_u32_u24 v48, v47, s7, v46
    v_add_u32 v49, s97, v48
    v_mad_u32_u24 v45, v44, s96, v45
    v_mul_u32_u24 v45, 1152, v45
    v_lshl_add_u32 v44, v47, 4, v45
    s_add_u32 s58, s50, s48
    s_add_u32 m0, s101, 0
    s_nop 0
    buffer_load_dwordx4 v4, s[28:31], s58 offen offset:0 lds
    buffer_load_dwordx4 v5, s[28:31], s58 offen offset:1024 lds
    buffer_load_dwordx4 v6, s[28:31], s58 offen offset:2048 lds
    buffer_load_dwordx4 v7, s[28:31], s58 offen offset:3072 lds
    s_mov_b32 m0, s20
    s_nop 0
    buffer_load_dwordx4 v44, s[36:39], s17 offen lds
    s_add_u32 m0, s20, 1024
    s_nop 0
    buffer_load_dwordx4 v44, s[40:43], s21 offen lds
    s_add_u32 s58, s50, s49
    s_add_u32 m0, s101, 4096
    s_nop 0
    buffer_load_dwordx4 v4, s[28:31], s58 offen offset:0 lds
    buffer_load_dwordx4 v5, s[28:31], s58 offen offset:1024 lds
    buffer_load_dwordx4 v6, s[28:31], s58 offen offset:2048 lds
    buffer_load_dwordx4 v7, s[28:31], s58 offen offset:3072 lds
    s_add_u32 s50, s50, 128
    s_cmp_eq_u32 s50, 1152
    s_cselect_b32 s50, 0, s50
    s_add_u32 s58, s50, s48
    s_add_u32 m0, s101, 8192
    s_nop 0
    buffer_load_dwordx4 v4, s[28:31], s58 offen offset:0 lds
    buffer_load_dwordx4 v5, s[28:31], s58 offen offset:1024 lds
    buffer_load_dwordx4 v6, s[28:31], s58 offen offset:2048 lds
    buffer_load_dwordx4 v7, s[28:31], s58 offen offset:3072 lds
    s_add_u32 s58, s50, s49
    s_add_u32 m0, s101, 12288
    s_nop 0
    buffer_load_dwordx4 v4, s[28:31], s58 offen offset:0 lds
    buffer_load_dwordx4 v5, s[28:31], s58 offen offset:1024 lds
    buffer_load_dwordx4 v6, s[28:31], s58 offen offset:2048 lds
    buffer_load_dwordx4 v7, s[28:31], s58 offen offset:3072 lds
    s_add_u32 s50, s50, 128
    s_cmp_eq_u32 s50, 1152
    s_cselect_b32 s50, 0, s50
    s_waitcnt lgkmcnt(0)
    s_branch P0J
ol_4:
wp_2:
    buffer_load_dwordx2 v[32:33], v12, s[32:35], s59 offen sc1
    s_add_u32 s100, s100, 1
    s_waitcnt vmcnt(0)
    v_cmp_ne_u64 vcc, s[56:57], v[32:33]
    s_and_b64 s[96:97], vcc, -1
    s_cbranch_scc0 wd_3
    s_cmp_lt_u32 s100, 20000
    s_cbranch_scc1 wp_2
    s_branch wd_3
ol_7:
    s_mov_b32 s100, 0
pl_5:
    buffer_load_dwordx2 v[4:5], v6, s[32:35], s9 offen sc1
    s_add_u32 s100, s100, 1
    s_waitcnt vmcnt(0)
    v_cmp_ne_u64 vcc, s[56:57], v[4:5]
    s_cmp_eq_u64 vcc, 0
    s_cbranch_scc1 pd_6
    s_cmp_lt_u32 s100, 20000
    s_cbranch_scc1 pl_5
    s_branch pd_6
ol_10:
    s_mov_b32 s100, 0
pl_8:
    buffer_load_dwordx2 v[98:99], off, s[32:35], s36 sc1
    s_add_u32 s100, s100, 1
    s_waitcnt vmcnt(0)
    v_cmp_ne_u64 vcc, s[56:57], v[98:99]
    s_cmp_eq_u64 vcc, 0
    s_cbranch_scc1 pd_9
    s_cmp_lt_u32 s100, 20000
    s_cbranch_scc1 pl_8
    s_branch pd_9
ZPREV:
    v_mov_b32 v216, 0
    v_mov_b32 v217, 0
    v_mov_b32 v218, 0
    v_mov_b32 v219, 0
    ds_write_b128 v4, v[216:219] offset:0
    ds_write_b128 v4, v[216:219] offset:1024
    ds_write_b128 v5, v[216:219] offset:0
    ds_write_b128 v5, v[216:219] offset:1024
    ds_write_b128 v6, v[216:219] offset:2048
    s_waitcnt vmcnt(0) lgkmcnt(0)
    s_branch PREVJ
ol_13:
    s_mov_b32 s100, 0
pl_11:
    buffer_load_dwordx2 v[98:99], v124, s[32:35], s19 offen sc1
    s_add_u32 s100, s100, 1
    s_waitcnt vmcnt(0)
    v_cmp_ne_u64 vcc, s[56:57], v[98:99]
    s_cmp_eq_u64 vcc, 0
    s_cbranch_scc1 pd_12
    s_cmp_lt_u32 s100, 20000
    s_cbranch_scc1 pl_11
    s_branch pd_12
ol_16:
    s_mov_b32 s100, 0
dl_14:
    buffer_load_dwordx4 v[240:243], v2, s[32:35], s39 offen offset:0 sc1
    buffer_load_dwordx4 v[244:247], v2, s[32:35], s39 offen offset:1024 sc1
    buffer_load_dwordx4 v[248:251], v2, s[32:35], s39 offen offset:2048 sc1
    buffer_load_dwordx4 v[252:255], v2, s[32:35], s39 offen offset:3072 sc1
    buffer_load_dwordx4 v[108:111], v7, s[32:35], s39 offen offset:0 sc1
    buffer_load_dwordx4 v[112:115], v7, s[32:35], s39 offen offset:1024 sc1
    buffer_load_dwordx4 v[116:119], v7, s[32:35], s39 offen offset:2048 sc1
    buffer_load_dwordx4 v[120:123], v7, s[32:35], s39 offen offset:3072 sc1
    s_add_u32 s100, s100, 1
    s_waitcnt vmcnt(0)
    v_max3_u32 v236, v240, v241, v240
    v_max3_u32 v237, v242, v243, v242
    v_max3_u32 v236, v244, v245, v236
    v_max3_u32 v237, v246, v247, v237
    v_max3_u32 v236, v248, v249, v236
    v_max3_u32 v237, v250, v251, v237
    v_max3_u32 v236, v252, v253, v236
    v_max3_u32 v237, v254, v255, v237
    v_max3_u32 v236, v108, v109, v236
    v_max3_u32 v237, v110, v111, v237
    v_max3_u32 v236, v112, v113, v236
    v_max3_u32 v237, v114, v115, v237
    v_max3_u32 v236, v116, v117, v236
    v_max3_u32 v237, v118, v119, v237
    v_max3_u32 v236, v120, v121, v236
    v_max3_u32 v237, v122, v123, v237
    v_max_u32 v236, v236, v237
    v_cmp_eq_u32 vcc, -1, v236
    s_cmp_eq_u64 vcc, 0
    s_cbranch_scc1 dd_15
    s_cmp_lt_u32 s100, 20000
    s_cbranch_scc1 dl_14
    s_branch dd_15
ol_35:
    s_mov_b32 s100, 0
dl_33:
    buffer_load_dwordx4 v[220:223], v2, s[32:35], s48 offen offset:0 sc1
    buffer_load_dwordx4 v[224:227], v2, s[32:35], s48 offen offset:1024 sc1
    buffer_load_dwordx4 v[228:231], v2, s[32:35], s48 offen offset:2048 sc1
    buffer_load_dwordx4 v[232:235], v2, s[32:35], s48 offen offset:3072 sc1
    s_add_u32 s100, s100, 1
    s_waitcnt vmcnt(0)
    v_max3_u32 v120, v220, v221, v220
    v_max3_u32 v121, v222, v223, v222
    v_max3_u32 v120, v224, v225, v120
    v_max3_u32 v121, v226, v227, v121
    v_max3_u32 v120, v228, v229, v120
    v_max3_u32 v121, v230, v231, v121
    v_max3_u32 v120, v232, v233, v120
    v_max3_u32 v121, v234, v235, v121
    v_max_u32 v120, v120, v121
    v_cmp_eq_u32 vcc, -1, v120
    s_cmp_eq_u64 vcc, 0
    s_cbranch_scc1 dd_34
    s_cmp_lt_u32 s100, 20000
    s_cbranch_scc1 dl_33
    s_branch dd_34
ol_38:
    s_mov_b32 s100, 0
dl_36:
    buffer_load_dwordx4 v[240:243], v2, s[32:35], s49 offen offset:0 sc1
    buffer_load_dwordx4 v[244:247], v2, s[32:35], s49 offen offset:1024 sc1
    buffer_load_dwordx4 v[248:251], v2, s[32:35], s49 offen offset:2048 sc1
    buffer_load_dwordx4 v[252:255], v2, s[32:35], s49 offen offset:3072 sc1
    s_add_u32 s100, s100, 1
    s_waitcnt vmcnt(0)
    v_max3_u32 v120, v240, v241, v240
    v_max3_u32 v121, v242, v243, v242
    v_max3_u32 v120, v244, v245, v120
    v_max3_u32 v121, v246, v247, v121
    v_max3_u32 v120, v248, v249, v120
    v_max3_u32 v121, v250, v251, v121
    v_max3_u32 v120, v252, v253, v120
    v_max3_u32 v121, v254, v255, v121
    v_max_u32 v120, v120, v121
    v_cmp_eq_u32 vcc, -1, v120
    s_cmp_eq_u64 vcc, 0
    s_cbranch_scc1 dd_37
    s_cmp_lt_u32 s100, 20000
    s_cbranch_scc1 dl_36
    s_branch dd_37
ol_41:
    s_mov_b32 s100, 0
dl_39:
    buffer_load_dwordx4 v[100:103], v2, s[32:35], s50 offen offset:0 sc1
    buffer_load_dwordx4 v[104:107], v2, s[32:35], s50 offen offset:1024 sc1
    buffer_load_dwordx4 v[108:111], v2, s[32:35], s50 offen offset:2048 sc1
    buffer_load_dwordx4 v[112:115], v2, s[32:35], s50 offen offset:3072 sc1
    buffer_load_dwordx2 v[116:117], v9, s[32:35], s50 offen offset:0 sc1
    buffer_load_dwordx2 v[118:119], v9, s[32:35], s50 offen offset:128 sc1
    s_add_u32 s100, s100, 1
    s_waitcnt vmcnt(0)
    v_max3_u32 v120, v100, v101, v100
    v_max3_u32 v121, v102, v103, v102
    v_max3_u32 v120, v104, v105, v120
    v_max3_u32 v121, v106, v107, v121
    v_max3_u32 v120, v108, v109, v120
    v_max3_u32 v121, v110, v111, v121
    v_max3_u32 v120, v112, v113, v120
    v_max3_u32 v121, v114, v115, v121
    v_max3_u32 v120, v116, v117, v120
    v_max3_u32 v121, v118, v119, v121
    v_max_u32 v120, v120, v121
    v_cmp_eq_u32 vcc, -1, v120
    s_cmp_eq_u64 vcc, 0
    s_cbranch_scc1 dd_40
    s_cmp_lt_u32 s100, 20000
    s_cbranch_scc1 dl_39
    s_branch dd_40
ol_44:
    s_mov_b32 s100, 0
dl_42:
    buffer_load_dwordx4 v[156:159], v2, s[32:35], s51 offen offset:0 sc1
    buffer_load_dwordx4 v[160:163], v2, s[32:35], s51 offen offset:1024 sc1
    buffer_load_dwordx4 v[164:167], v2, s[32:35], s51 offen offset:2048 sc1
    buffer_load_dwordx4 v[168:171], v2, s[32:35], s51 offen offset:3072 sc1
    buffer_load_dwordx2 v[124:125], v9, s[32:35], s51 offen offset:0 sc1
    buffer_load_dwordx2 v[126:127], v9, s[32:35], s51 offen offset:128 sc1
    s_add_u32 s100, s100, 1
    s_waitcnt vmcnt(0)
    v_max3_u32 v120, v156, v157, v156
    v_max3_u32 v121, v158, v159, v158
    v_max3_u32 v120, v160, v161, v120
    v_max3_u32 v121, v162, v163, v121
    v_max3_u32 v120, v164, v165, v120
    v_max3_u32 v121, v166, v167, v121
    v_max3_u32 v120, v168, v169, v120
    v_max3_u32 v121, v170, v171, v121
    v_max3_u32 v120, v124, v125, v120
    v_max3_u32 v121, v126, v127, v121
    v_max_u32 v120, v120, v121
    v_cmp_eq_u32 vcc, -1, v120
    s_cmp_eq_u64 vcc, 0
    s_cbranch_scc1 dd_43
    s_cmp_lt_u32 s100, 20000
    s_cbranch_scc1 dl_42
    s_branch dd_43
ol_45:
    v_mov_b32 v36, s56
    v_mov_b32 v37, s57
    s_mov_b64 exec, 1
    buffer_store_dwordx2 v[36:37], off, s[32:35], 0 sc1
    s_mov_b64 exec, -1
    s_branch NOEP
REC0:
    s_mov_b32 s99, m0
    s_mov_b32 s100, 0
    s_add_u32 s98, s55, 0
    s_cmp_ge_u32 s98, 9
    s_cselect_b32 s96, 9, 0
    s_sub_u32 s98, s98, s96
    s_mul_i32 s98, s98, 14336
    s_add_u32 s98, s98, s51
    s_add_u32 m0, s62, 98304
RL0:
    s_waitcnt lgkmcnt(0)
    s_barrier
    buffer_load_dwordx4 v2, s[32:35], s98 offen offset:0 sc1 lds
    buffer_load_dwordx4 v2, s[32:35], s98 offen offset:1024 sc1 lds
    buffer_load_dwordx4 v2, s[32:35], s98 offen offset:2048 sc1 lds
    s_mov_b32 exec_hi, 0
    buffer_load_dwordx4 v2, s[32:35], s98 offen offset:3072 sc1 lds
    s_mov_b32 exec_hi, -1
    s_add_u32 s100, s100, 1
    s_waitcnt vmcnt(0)
    s_barrier
    ds_read_b128 v[72:75], v10 offset:0
    ds_read_b128 v[76:79], v10 offset:1024
    ds_read_b128 v[80:83], v10 offset:2048
    ds_read_b128 v[84:87], v10 offset:3072
    ds_read_b128 v[88:91], v10 offset:4096
    ds_read_b128 v[92:95], v10 offset:5120
    ds_read_b128 v[96:99], v11 offset:0
    s_waitcnt lgkmcnt(4)
    v_max3_u32 v33, v72, v76, v80
    s_waitcnt lgkmcnt(2)
    v_max3_u32 v33, v84, v88, v33
    s_waitcnt lgkmcnt(0)
    v_max3_u32 v33, v92, v96, v33
    v_cmp_eq_u32 s[96:97], -1, v33
    s_cmp_lt_u32 s100, 20000
    s_cselect_b64 s[96:97], s[96:97], 0
    s_cmp_lg_u64 s[96:97], 0
    s_cbranch_scc1 RL0
    s_mov_b32 m0, s99
    s_branch BK0
REC1:
    s_mov_b32 s99, m0
    s_mov_b32 s100, 0
    s_add_u32 s98, s55, 0
    s_cmp_ge_u32 s98, 9
    s_cselect_b32 s96, 9, 0
    s_sub_u32 s98, s98, s96
    s_mul_i32 s98, s98, 14336
    s_add_u32 s98, s98, s51
    s_add_u32 m0, s62, 98304
RL1:
    s_waitcnt lgkmcnt(0)
    s_barrier
    buffer_load_dwordx4 v2, s[32:35], s98 offen offset:0 sc1 lds
    buffer_load_dwordx4 v2, s[32:35], s98 offen offset:1024 sc1 lds
    buffer_load_dwordx4 v2, s[32:35], s98 offen offset:2048 sc1 lds
    s_mov_b32 exec_hi, 0
    buffer_load_dwordx4 v2, s[32:35], s98 offen offset:3072 sc1 lds
    s_mov_b32 exec_hi, -1
    s_add_u32 s100, s100, 1
    s_waitcnt vmcnt(0)
    s_barrier
    ds_read_b128 v[100:103], v10 offset:7168
    ds_read_b128 v[104:107], v10 offset:8192
    ds_read_b128 v[108:111], v10 offset:9216
    ds_read_b128 v[112:115], v10 offset:10240
    ds_read_b128 v[116:119], v10 offset:11264
    ds_read_b128 v[120:123], v10 offset:12288
    ds_read_b128 v[124:127], v11 offset:7168
    s_waitcnt lgkmcnt(4)
    v_max3_u32 v33, v100, v104, v108
    s_waitcnt lgkmcnt(2)
    v_max3_u32 v33, v112, v116, v33
    s_waitcnt lgkmcnt(0)
    v_max3_u32 v33, v120, v124, v33
    v_cmp_eq_u32 s[96:97], -1, v33
    s_cmp_lt_u32 s100, 20000
    s_cselect_b64 s[96:97], s[96:97], 0
    s_cmp_lg_u64 s[96:97], 0
    s_cbranch_scc1 RL1
    s_mov_b32 m0, s99
    s_branch BK1
REC2:
    s_mov_b32 s99, m0
    s_mov_b32 s100, 0
    s_add_u32 s98, s55, 1
    s_cmp_ge_u32 s98, 9
    s_cselect_b32 s96, 9, 0
    s_sub_u32 s98, s98, s96
    s_mul_i32 s98, s98, 14336
    s_add_u32 s98, s98, s51
    s_add_u32 m0, s62, 112640
RL2:
    s_waitcnt lgkmcnt(0)
    s_barrier
    buffer_load_dwordx4 v2, s[32:35], s98 offen offset:0 sc1 lds
    buffer_load_dwordx4 v2, s[32:35], s98 offen offset:1024 sc1 lds
    buffer_load_dwordx4 v2, s[32:35], s98 offen offset:2048 sc1 lds
    s_mov_b32 exec_hi, 0
    buffer_load_dwordx4 v2, s[32:35], s98 offen offset:3072 sc1 lds
    s_mov_b32 exec_hi, -1
    s_add_u32 s100, s100, 1
    s_waitcnt vmcnt(0)
    s_barrier
    ds_read_b128 v[72:75], v10 offset:14336
    ds_read_b128 v[76:79], v10 offset:15360
    ds_read_b128 v[80:83], v10 offset:16384
    ds_read_b128 v[84:87], v10 offset:17408
    ds_read_b128 v[88:91], v10 offset:18432
    ds_read_b128 v[92:95], v10 offset:19456
    ds_read_b128 v[96:99], v11 offset:14336
    s_waitcnt lgkmcnt(4)
    v_max3_u32 v33, v72, v76, v80
    s_waitcnt lgkmcnt(2)
    v_max3_u32 v33, v84, v88, v33
    s_waitcnt lgkmcnt(0)
    v_max3_u32 v33, v92, v96, v33
    v_cmp_eq_u32 s[96:97], -1, v33
    s_cmp_lt_u32 s100, 20000
    s_cselect_b64 s[96:97], s[96:97], 0
    s_cmp_lg_u64 s[96:97], 0
    s_cbranch_scc1 RL2
    s_mov_b32 m0, s99
    s_branch BK2
REC3:
    s_mov_b32 s99, m0
    s_mov_b32 s100, 0
    s_add_u32 s98, s55, 1
    s_cmp_ge_u32 s98, 9
    s_cselect_b32 s96, 9, 0
    s_sub_u32 s98, s98, s96
    s_mul_i32 s98, s98, 14336
    s_add_u32 s98, s98, s51
    s_add_u32 m0, s62, 112640
RL3:
    s_waitcnt lgkmcnt(0)
    s_barrier
    buffer_load_dwordx4 v2, s[32:35], s98 offen offset:0 sc1 lds
    buffer_load_dwordx4 v2, s[32:35], s98 offen offset:1024 sc1 lds
    buffer_load_dwordx4 v2, s[32:35], s98 offen offset:2048 sc1 lds
    s_mov_b32 exec_hi, 0
    buffer_load_dwordx4 v2, s[32:35], s98 offen offset:3072 sc1 lds
    s_mov_b32 exec_hi, -1
    s_add_u32 s100, s100, 1
    s_waitcnt vmcnt(0)
    s_barrier
    ds_read_b128 v[100:103], v10 offset:21504
    ds_read_b128 v[104:107], v10 offset:22528
    ds_read_b128 v[108:111], v10 offset:23552
    ds_read_b128 v[112:115], v10 offset:24576
    ds_read_b128 v[116:119], v10 offset:25600
    ds_read_b128 v[120:123], v10 offset:26624
    ds_read_b128 v[124:127], v11 offset:21504
    s_waitcnt lgkmcnt(4)
    v_max3_u32 v33, v100, v104, v108
    s_waitcnt lgkmcnt(2)
    v_max3_u32 v33, v112, v116, v33
    s_waitcnt lgkmcnt(0)
    v_max3_u32 v33, v120, v124, v33
    v_cmp_eq_u32 s[96:97], -1, v33
    s_cmp_lt_u32 s100, 20000
    s_cselect_b64 s[96:97], s[96:97], 0
    s_cmp_lg_u64 s[96:97], 0
    s_cbranch_scc1 RL3
    s_mov_b32 m0, s99
    s_branch BK3
REC4:
    s_mov_b32 s99, m0
    s_mov_b32 s100, 0
    s_add_u32 s98, s55, 2
    s_cmp_ge_u32 s98, 9
    s_cselect_b32 s96, 9, 0
    s_sub_u32 s98, s98, s96
    s_mul_i32 s98, s98, 14336
    s_add_u32 s98, s98, s51
    s_add_u32 m0, s62, 126976
RL4:
    s_waitcnt lgkmcnt(0)
    s_barrier
    buffer_load_dwordx4 v2, s[32:35], s98 offen offset:0 sc1 lds
    buffer_load_dwordx4 v2, s[32:35], s98 offen offset:1024 sc1 lds
    buffer_load_dwordx4 v2, s[32:35], s98 offen offset:2048 sc1 lds
    s_mov_b32 exec_hi, 0
    buffer_load_dwordx4 v2, s[32:35], s98 offen offset:3072 sc1 lds
    s_mov_b32 exec_hi, -1
    s_add_u32 s100, s100, 1
    s_waitcnt vmcnt(0)
    s_barrier
    ds_read_b128 v[72:75], v10 offset:28672
    ds_read_b128 v[76:79], v10 offset:29696
    ds_read_b128 v[80:83], v10 offset:30720
    ds_read_b128 v[84:87], v10 offset:31744
    ds_read_b128 v[88:91], v10 offset:32768
    ds_read_b128 v[92:95], v10 offset:33792
    ds_read_b128 v[96:99], v11 offset:28672
    s_waitcnt lgkmcnt(4)
    v_max3_u32 v33, v72, v76, v80
    s_waitcnt lgkmcnt(2)
    v_max3_u32 v33, v84, v88, v33
    s_waitcnt lgkmcnt(0)
    v_max3_u32 v33, v92, v96, v33
    v_cmp_eq_u32 s[96:97], -1, v33
    s_cmp_lt_u32 s100, 20000
    s_cselect_b64 s[96:97], s[96:97], 0
    s_cmp_lg_u64 s[96:97], 0
    s_cbranch_scc1 RL4
    s_mov_b32 m0, s99
    s_branch BK4
REC5:
    s_mov_b32 s99, m0
    s_mov_b32 s100, 0
    s_add_u32 s98, s55, 2
    s_cmp_ge_u32 s98, 9
    s_cselect_b32 s96, 9, 0
    s_sub_u32 s98, s98, s96
    s_mul_i32 s98, s98, 14336
    s_add_u32 s98, s98, s51
    s_add_u32 m0, s62, 126976
RL5:
    s_waitcnt lgkmcnt(0)
    s_barrier
    buffer_load_dwordx4 v2, s[32:35], s98 offen offset:0 sc1 lds
    buffer_load_dwordx4 v2, s[32:35], s98 offen offset:1024 sc1 lds
    buffer_load_dwordx4 v2, s[32:35], s98 offen offset:2048 sc1 lds
    s_mov_b32 exec_hi, 0
    buffer_load_dwordx4 v2, s[32:35], s98 offen offset:3072 sc1 lds
    s_mov_b32 exec_hi, -1
    s_add_u32 s100, s100, 1
    s_waitcnt vmcnt(0)
    s_barrier
    ds_read_b128 v[100:103], v10 offset:35840
    ds_read_b128 v[104:107], v10 offset:36864
    ds_read_b128 v[108:111], v10 offset:37888
    ds_read_b128 v[112:115], v10 offset:38912
    ds_read_b128 v[116:119], v10 offset:39936
    ds_read_b128 v[120:123], v10 offset:40960
    ds_read_b128 v[124:127], v11 offset:35840
    s_waitcnt lgkmcnt(4)
    v_max3_u32 v33, v100, v104, v108
    s_waitcnt lgkmcnt(2)
    v_max3_u32 v33, v112, v116, v33
    s_waitcnt lgkmcnt(0)
    v_max3_u32 v33, v120, v124, v33
    v_cmp_eq_u32 s[96:97], -1, v33
    s_cmp_lt_u32 s100, 20000
    s_cselect_b64 s[96:97], s[96:97], 0
    s_cmp_lg_u64 s[96:97], 0
    s_cbranch_scc1 RL5
    s_mov_b32 m0, s99
    s_branch BK5
REC6:
    s_mov_b32 s99, m0
    s_mov_b32 s100, 0
    s_add_u32 s98, s55, 3
    s_cmp_ge_u32 s98, 9
    s_cselect_b32 s96, 9, 0
    s_sub_u32 s98, s98, s96
    s_mul_i32 s98, s98, 14336
    s_add_u32 s98, s98, s51
    s_add_u32 m0, s62, 141312
RL6:
    s_waitcnt lgkmcnt(0)
    s_barrier
    buffer_load_dwordx4 v2, s[32:35], s98 offen offset:0 sc1 lds
    buffer_load_dwordx4 v2, s[32:35], s98 offen offset:1024 sc1 lds
    buffer_load_dwordx4 v2, s[32:35], s98 offen offset:2048 sc1 lds
    s_mov_b32 exec_hi, 0
    buffer_load_dwordx4 v2, s[32:35], s98 offen offset:3072 sc1 lds
    s_mov_b32 exec_hi, -1
    s_add_u32 s100, s100, 1
    s_waitcnt vmcnt(0)
    s_barrier
    ds_read_b128 v[72:75], v10 offset:43008
    ds_read_b128 v[76:79], v10 offset:44032
    ds_read_b128 v[80:83], v10 offset:45056
    ds_read_b128 v[84:87], v10 offset:46080
    ds_read_b128 v[88:91], v10 offset:47104
    ds_read_b128 v[92:95], v10 offset:48128
    ds_read_b128 v[96:99], v11 offset:43008
    s_waitcnt lgkmcnt(4)
    v_max3_u32 v33, v72, v76, v80
    s_waitcnt lgkmcnt(2)
    v_max3_u32 v33, v84, v88, v33
    s_waitcnt lgkmcnt(0)
    v_max3_u32 v33, v92, v96, v33
    v_cmp_eq_u32 s[96:97], -1, v33
    s_cmp_lt_u32 s100, 20000
    s_cselect_b64 s[96:97], s[96:97], 0
    s_cmp_lg_u64 s[96:97], 0
    s_cbranch_scc1 RL6
    s_mov_b32 m0, s99
    s_branch BK6
REC7:
    s_mov_b32 s99, m0
    s_mov_b32 s100, 0
    s_add_u32 s98, s55, 3
    s_cmp_ge_u32 s98, 9
    s_cselect_b32 s96, 9, 0
    s_sub_u32 s98, s98, s96
    s_mul_i32 s98, s98, 14336
    s_add_u32 s98, s98, s51
    s_add_u32 m0, s62, 141312
RL7:
    s_waitcnt lgkmcnt(0)
    s_barrier
    buffer_load_dwordx4 v2, s[32:35], s98 offen offset:0 sc1 lds
    buffer_load_dwordx4 v2, s[32:35], s98 offen offset:1024 sc1 lds
    buffer_load_dwordx4 v2, s[32:35], s98 offen offset:2048 sc1 lds
    s_mov_b32 exec_hi, 0
    buffer_load_dwordx4 v2, s[32:35], s98 offen offset:3072 sc1 lds
    s_mov_b32 exec_hi, -1
    s_add_u32 s100, s100, 1
    s_waitcnt vmcnt(0)
    s_barrier
    ds_read_b128 v[100:103], v10 offset:50176
    ds_read_b128 v[104:107], v10 offset:51200
    ds_read_b128 v[108:111], v10 offset:52224
    ds_read_b128 v[112:115], v10 offset:53248
    ds_read_b128 v[116:119], v10 offset:54272
    ds_read_b128 v[120:123], v10 offset:55296
    ds_read_b128 v[124:127], v11 offset:50176
    s_waitcnt lgkmcnt(4)
    v_max3_u32 v33, v100, v104, v108
    s_waitcnt lgkmcnt(2)
    v_max3_u32 v33, v112, v116, v33
    s_waitcnt lgkmcnt(0)
    v_max3_u32 v33, v120, v124, v33
    v_cmp_eq_u32 s[96:97], -1, v33
    s_cmp_lt_u32 s100, 20000
    s_cselect_b64 s[96:97], s[96:97], 0
    s_cmp_lg_u64 s[96:97], 0
    s_cbranch_scc1 RL7
    s_mov_b32 m0, s99
    s_branch BK7
REC8:
    s_mov_b32 s99, m0
    s_mov_b32 s100, 0
    s_add_u32 s98, s55, 4
    s_cmp_ge_u32 s98, 9
    s_cselect_b32 s96, 9, 0
    s_sub_u32 s98, s98, s96
    s_mul_i32 s98, s98, 14336
    s_add_u32 s98, s98, s51
    s_add_u32 m0, s62, 98304
RL8:
    s_waitcnt lgkmcnt(0)
    s_barrier
    buffer_load_dwordx4 v2, s[32:35], s98 offen offset:0 sc1 lds
    buffer_load_dwordx4 v2, s[32:35], s98 offen offset:1024 sc1 lds
    buffer_load_dwordx4 v2, s[32:35], s98 offen offset:2048 sc1 lds
    s_mov_b32 exec_hi, 0
    buffer_load_dwordx4 v2, s[32:35], s98 offen offset:3072 sc1 lds
    s_mov_b32 exec_hi, -1
    s_add_u32 s100, s100, 1
    s_waitcnt vmcnt(0)
    s_barrier
    ds_read_b128 v[72:75], v10 offset:0
    ds_read_b128 v[76:79], v10 offset:1024
    ds_read_b128 v[80:83], v10 offset:2048
    ds_read_b128 v[84:87], v10 offset:3072
    ds_read_b128 v[88:91], v10 offset:4096
    ds_read_b128 v[92:95], v10 offset:5120
    ds_read_b128 v[96:99], v11 offset:0
    s_waitcnt lgkmcnt(4)
    v_max3_u32 v33, v72, v76, v80
    s_waitcnt lgkmcnt(2)
    v_max3_u32 v33, v84, v88, v33
    s_waitcnt lgkmcnt(0)
    v_max3_u32 v33, v92, v96, v33
    v_cmp_eq_u32 s[96:97], -1, v33
    s_cmp_lt_u32 s100, 20000
    s_cselect_b64 s[96:97], s[96:97], 0
    s_cmp_lg_u64 s[96:97], 0
    s_cbranch_scc1 RL8
    s_mov_b32 m0, s99
    s_branch BK8
REC9:
    s_mov_b32 s99, m0
    s_mov_b32 s100, 0
    s_add_u32 s98, s55, 4
    s_cmp_ge_u32 s98, 9
    s_cselect_b32 s96, 9, 0
    s_sub_u32 s98, s98, s96
    s_mul_i32 s98, s98, 14336
    s_add_u32 s98, s98, s51
    s_add_u32 m0, s62, 98304
RL9:
    s_waitcnt lgkmcnt(0)
    s_barrier
    buffer_load_dwordx4 v2, s[32:35], s98 offen offset:0 sc1 lds
    buffer_load_dwordx4 v2, s[32:35], s98 offen offset:1024 sc1 lds
    buffer_load_dwordx4 v2, s[32:35], s98 offen offset:2048 sc1 lds
    s_mov_b32 exec_hi, 0
    buffer_load_dwordx4 v2, s[32:35], s98 offen offset:3072 sc1 lds
    s_mov_b32 exec_hi, -1
    s_add_u32 s100, s100, 1
    s_waitcnt vmcnt(0)
    s_barrier
    ds_read_b128 v[100:103], v10 offset:7168
    ds_read_b128 v[104:107], v10 offset:8192
    ds_read_b128 v[108:111], v10 offset:9216
    ds_read_b128 v[112:115], v10 offset:10240
    ds_read_b128 v[116:119], v10 offset:11264
    ds_read_b128 v[120:123], v10 offset:12288
    ds_read_b128 v[124:127], v11 offset:7168
    s_waitcnt lgkmcnt(4)
    v_max3_u32 v33, v100, v104, v108
    s_waitcnt lgkmcnt(2)
    v_max3_u32 v33, v112, v116, v33
    s_waitcnt lgkmcnt(0)
    v_max3_u32 v33, v120, v124, v33
    v_cmp_eq_u32 s[96:97], -1, v33
    s_cmp_lt_u32 s100, 20000
    s_cselect_b64 s[96:97], s[96:97], 0
    s_cmp_lg_u64 s[96:97], 0
    s_cbranch_scc1 RL9
    s_mov_b32 m0, s99
    s_branch BK9
REC10:
    s_mov_b32 s99, m0
    s_mov_b32 s100, 0
    s_add_u32 s98, s55, 5
    s_cmp_ge_u32 s98, 9
    s_cselect_b32 s96, 9, 0
    s_sub_u32 s98, s98, s96
    s_mul_i32 s98, s98, 14336
    s_add_u32 s98, s98, s51
    s_add_u32 m0, s62, 112640
RL10:
    s_waitcnt lgkmcnt(0)
    s_barrier
    buffer_load_dwordx4 v2, s[32:35], s98 offen offset:0 sc1 lds
    buffer_load_dwordx4 v2, s[32:35], s98 offen offset:1024 sc1 lds
    buffer_load_dwordx4 v2, s[32:35], s98 offen offset:2048 sc1 lds
    s_mov_b32 exec_hi, 0
    buffer_load_dwordx4 v2, s[32:35], s98 offen offset:3072 sc1 lds
    s_mov_b32 exec_hi, -1
    s_add_u32 s100, s100, 1
    s_waitcnt vmcnt(0)
    s_barrier
    ds_read_b128 v[72:75], v10 offset:14336
    ds_read_b128 v[76:79], v10 offset:15360
    ds_read_b128 v[80:83], v10 offset:16384
    ds_read_b128 v[84:87], v10 offset:17408
    ds_read_b128 v[88:91], v10 offset:18432
    ds_read_b128 v[92:95], v10 offset:19456
    ds_read_b128 v[96:99], v11 offset:14336
    s_waitcnt lgkmcnt(4)
    v_max3_u32 v33, v72, v76, v80
    s_waitcnt lgkmcnt(2)
    v_max3_u32 v33, v84, v88, v33
    s_waitcnt lgkmcnt(0)
    v_max3_u32 v33, v92, v96, v33
    v_cmp_eq_u32 s[96:97], -1, v33
    s_cmp_lt_u32 s100, 20000
    s_cselect_b64 s[96:97], s[96:97], 0
    s_cmp_lg_u64 s[96:97], 0
    s_cbranch_scc1 RL10
    s_mov_b32 m0, s99
    s_branch BK10
REC11:
    s_mov_b32 s99, m0
    s_mov_b32 s100, 0
    s_add_u32 s98, s55, 5
    s_cmp_ge_u32 s98, 9
    s_cselect_b32 s96, 9, 0
    s_sub_u32 s98, s98, s96
    s_mul_i32 s98, s98, 14336
    s_add_u32 s98, s98, s51
    s_add_u32 m0, s62, 112640
RL11:
    s_waitcnt lgkmcnt(0)
    s_barrier
    buffer_load_dwordx4 v2, s[32:35], s98 offen offset:0 sc1 lds
    buffer_load_dwordx4 v2, s[32:35], s98 offen offset:1024 sc1 lds
    buffer_load_dwordx4 v2, s[32:35], s98 offen offset:2048 sc1 lds
    s_mov_b32 exec_hi, 0
    buffer_load_dwordx4 v2, s[32:35], s98 offen offset:3072 sc1 lds
    s_mov_b32 exec_hi, -1
    s_add_u32 s100, s100, 1
    s_waitcnt vmcnt(0)
    s_barrier
    ds_read_b128 v[100:103], v10 offset:21504
    ds_read_b128 v[104:107], v10 offset:22528
    ds_read_b128 v[108:111], v10 offset:23552
    ds_read_b128 v[112:115], v10 offset:24576
    ds_read_b128 v[116:119], v10 offset:25600
    ds_read_b128 v[120:123], v10 offset:26624
    ds_read_b128 v[124:127], v11 offset:21504
    s_waitcnt lgkmcnt(4)
    v_max3_u32 v33, v100, v104, v108
    s_waitcnt lgkmcnt(2)
    v_max3_u32 v33, v112, v116, v33
    s_waitcnt lgkmcnt(0)
    v_max3_u32 v33, v120, v124, v33
    v_cmp_eq_u32 s[96:97], -1, v33
    s_cmp_lt_u32 s100, 20000
    s_cselect_b64 s[96:97], s[96:97], 0
    s_cmp_lg_u64 s[96:97], 0
    s_cbranch_scc1 RL11
    s_mov_b32 m0, s99
    s_branch BK11
REC12:
    s_mov_b32 s99, m0
    s_mov_b32 s100, 0
    s_add_u32 s98, s55, 6
    s_cmp_ge_u32 s98, 9
    s_cselect_b32 s96, 9, 0
    s_sub_u32 s98, s98, s96
    s_mul_i32 s98, s98, 14336
    s_add_u32 s98, s98, s51
    s_add_u32 m0, s62, 126976
RL12:
    s_waitcnt lgkmcnt(0)
    s_barrier
    buffer_load_dwordx4 v2, s[32:35], s98 offen offset:0 sc1 lds
    buffer_load_dwordx4 v2, s[32:35], s98 offen offset:1024 sc1 lds
    buffer_load_dwordx4 v2, s[32:35], s98 offen offset:2048 sc1 lds
    s_mov_b32 exec_hi, 0
    buffer_load_dwordx4 v2, s[32:35], s98 offen offset:3072 sc1 lds
    s_mov_b32 exec_hi, -1
    s_add_u32 s100, s100, 1
    s_waitcnt vmcnt(0)
    s_barrier
    ds_read_b128 v[72:75], v10 offset:28672
    ds_read_b128 v[76:79], v10 offset:29696
    ds_read_b128 v[80:83], v10 offset:30720
    ds_read_b128 v[84:87], v10 offset:31744
    ds_read_b128 v[88:91], v10 offset:32768
    ds_read_b128 v[92:95], v10 offset:33792
    ds_read_b128 v[96:99], v11 offset:28672
    s_waitcnt lgkmcnt(4)
    v_max3_u32 v33, v72, v76, v80
    s_waitcnt lgkmcnt(2)
    v_max3_u32 v33, v84, v88, v33
    s_waitcnt lgkmcnt(0)
    v_max3_u32 v33, v92, v96, v33
    v_cmp_eq_u32 s[96:97], -1, v33
    s_cmp_lt_u32 s100, 20000
    s_cselect_b64 s[96:97], s[96:97], 0
    s_cmp_lg_u64 s[96:97], 0
    s_cbranch_scc1 RL12
    s_mov_b32 m0, s99
    s_branch BK12
REC13:
    s_mov_b32 s99, m0
    s_mov_b32 s100, 0
    s_add_u32 s98, s55, 6
    s_cmp_ge_u32 s98, 9
    s_cselect_b32 s96, 9, 0
    s_sub_u32 s98, s98, s96
    s_mul_i32 s98, s98, 14336
    s_add_u32 s98, s98, s51
    s_add_u32 m0, s62, 126976
RL13:
    s_waitcnt lgkmcnt(0)
    s_barrier
    buffer_load_dwordx4 v2, s[32:35], s98 offen offset:0 sc1 lds
    buffer_load_dwordx4 v2, s[32:35], s98 offen offset:1024 sc1 lds
    buffer_load_dwordx4 v2, s[32:35], s98 offen offset:2048 sc1 lds
    s_mov_b32 exec_hi, 0
    buffer_load_dwordx4 v2, s[32:35], s98 offen offset:3072 sc1 lds
    s_mov_b32 exec_hi, -1
    s_add_u32 s100, s100, 1
    s_waitcnt vmcnt(0)
    s_barrier
    ds_read_b128 v[100:103], v10 offset:35840
    ds_read_b128 v[104:107], v10 offset:36864
    ds_read_b128 v[108:111], v10 offset:37888
    ds_read_b128 v[112:115], v10 offset:38912
    ds_read_b128 v[116:119], v10 offset:39936
    ds_read_b128 v[120:123], v10 offset:40960
    ds_read_b128 v[124:127], v11 offset:35840
    s_waitcnt lgkmcnt(4)
    v_max3_u32 v33, v100, v104, v108
    s_waitcnt lgkmcnt(2)
    v_max3_u32 v33, v112, v116, v33
    s_waitcnt lgkmcnt(0)
    v_max3_u32 v33, v120, v124, v33
    v_cmp_eq_u32 s[96:97], -1, v33
    s_cmp_lt_u32 s100, 20000
    s_cselect_b64 s[96:97], s[96:97], 0
    s_cmp_lg_u64 s[96:97], 0
    s_cbranch_scc1 RL13
    s_mov_b32 m0, s99
    s_branch BK13
REC14:
    s_mov_b32 s99, m0
    s_mov_b32 s100, 0
    s_add_u32 s98, s55, 7
    s_cmp_ge_u32 s98, 9
    s_cselect_b32 s96, 9, 0
    s_sub_u32 s98, s98, s96
    s_mul_i32 s98, s98, 14336
    s_add_u32 s98, s98, s51
    s_add_u32 m0, s62, 141312
RL14:
    s_waitcnt lgkmcnt(0)
    s_barrier
    buffer_load_dwordx4 v2, s[32:35], s98 offen offset:0 sc1 lds
    buffer_load_dwordx4 v2, s[32:35], s98 offen offset:1024 sc1 lds
    buffer_load_dwordx4 v2, s[32:35], s98 offen offset:2048 sc1 lds
    s_mov_b32 exec_hi, 0
    buffer_load_dwordx4 v2, s[32:35], s98 offen offset:3072 sc1 lds
    s_mov_b32 exec_hi, -1
    s_add_u32 s100, s100, 1
    s_waitcnt vmcnt(0)
    s_barrier
    ds_read_b128 v[72:75], v10 offset:43008
    ds_read_b128 v[76:79], v10 offset:44032
    ds_read_b128 v[80:83], v10 offset:45056
    ds_read_b128 v[84:87], v10 offset:46080
    ds_read_b128 v[88:91], v10 offset:47104
    ds_read_b128 v[92:95], v10 offset:48128
    ds_read_b128 v[96:99], v11 offset:43008
    s_waitcnt lgkmcnt(4)
    v_max3_u32 v33, v72, v76, v80
    s_waitcnt lgkmcnt(2)
    v_max3_u32 v33, v84, v88, v33
    s_waitcnt lgkmcnt(0)
    v_max3_u32 v33, v92, v96, v33
    v_cmp_eq_u32 s[96:97], -1, v33
    s_cmp_lt_u32 s100, 20000
    s_cselect_b64 s[96:97], s[96:97], 0
    s_cmp_lg_u64 s[96:97], 0
    s_cbranch_scc1 RL14
    s_mov_b32 m0, s99
    s_branch BK14
REC15:
    s_mov_b32 s99, m0
    s_mov_b32 s100, 0
    s_add_u32 s98, s55, 7
    s_cmp_ge_u32 s98, 9
    s_cselect_b32 s96, 9, 0
    s_sub_u32 s98, s98, s96
    s_mul_i32 s98, s98, 14336
    s_add_u32 s98, s98, s51
    s_add_u32 m0, s62, 141312
RL15:
    s_waitcnt lgkmcnt(0)
    s_barrier
    buffer_load_dwordx4 v2, s[32:35], s98 offen offset:0 sc1 lds
    buffer_load_dwordx4 v2, s[32:35], s98 offen offset:1024 sc1 lds
    buffer_load_dwordx4 v2, s[32:35], s98 offen offset:2048 sc1 lds
    s_mov_b32 exec_hi, 0
    buffer_load_dwordx4 v2, s[32:35], s98 offen offset:3072 sc1 lds
    s_mov_b32 exec_hi, -1
    s_add_u32 s100, s100, 1
    s_waitcnt vmcnt(0)
    s_barrier
    ds_read_b128 v[100:103], v10 offset:50176
    ds_read_b128 v[104:107], v10 offset:51200
    ds_read_b128 v[108:111], v10 offset:52224
    ds_read_b128 v[112:115], v10 offset:53248
    ds_read_b128 v[116:119], v10 offset:54272
    ds_read_b128 v[120:123], v10 offset:55296
    ds_read_b128 v[124:127], v11 offset:50176
    s_waitcnt lgkmcnt(4)
    v_max3_u32 v33, v100, v104, v108
    s_waitcnt lgkmcnt(2)
    v_max3_u32 v33, v112, v116, v33
    s_waitcnt lgkmcnt(0)
    v_max3_u32 v33, v120, v124, v33
    v_cmp_eq_u32 s[96:97], -1, v33
    s_cmp_lt_u32 s100, 20000
    s_cselect_b64 s[96:97], s[96:97], 0
    s_cmp_lg_u64 s[96:97], 0
    s_cbranch_scc1 RL15
    s_mov_b32 m0, s99
    s_branch BK15
REC16:
    s_mov_b32 s99, m0
    s_mov_b32 s100, 0
    s_add_u32 s98, s55, 8
    s_cmp_ge_u32 s98, 9
    s_cselect_b32 s96, 9, 0
    s_sub_u32 s98, s98, s96
    s_mul_i32 s98, s98, 14336
    s_add_u32 s98, s98, s51
    s_add_u32 m0, s62, 98304
RL16:
    s_waitcnt lgkmcnt(0)
    s_barrier
    buffer_load_dwordx4 v2, s[32:35], s98 offen offset:0 sc1 lds
    buffer_load_dwordx4 v2, s[32:35], s98 offen offset:1024 sc1 lds
    buffer_load_dwordx4 v2, s[32:35], s98 offen offset:2048 sc1 lds
    s_mov_b32 exec_hi, 0
    buffer_load_dwordx4 v2, s[32:35], s98 offen offset:3072 sc1 lds
    s_mov_b32 exec_hi, -1
    s_add_u32 s100, s100, 1
    s_waitcnt vmcnt(0)
    s_barrier
    ds_read_b128 v[72:75], v10 offset:0
    ds_read_b128 v[76:79], v10 offset:1024
    ds_read_b128 v[80:83], v10 offset:2048
    ds_read_b128 v[84:87], v10 offset:3072
    ds_read_b128 v[88:91], v10 offset:4096
    ds_read_b128 v[92:95], v10 offset:5120
    ds_read_b128 v[96:99], v11 offset:0
    s_waitcnt lgkmcnt(4)
    v_max3_u32 v33, v72, v76, v80
    s_waitcnt lgkmcnt(2)
    v_max3_u32 v33, v84, v88, v33
    s_waitcnt lgkmcnt(0)
    v_max3_u32 v33, v92, v96, v33
    v_cmp_eq_u32 s[96:97], -1, v33
    s_cmp_lt_u32 s100, 20000
    s_cselect_b64 s[96:97], s[96:97], 0
    s_cmp_lg_u64 s[96:97], 0
    s_cbranch_scc1 RL16
    s_mov_b32 m0, s99
    s_branch BK16
REC17:
    s_mov_b32 s99, m0
    s_mov_b32 s100, 0
    s_add_u32 s98, s55, 8
    s_cmp_ge_u32 s98, 9
    s_cselect_b32 s96, 9, 0
    s_sub_u32 s98, s98, s96
    s_mul_i32 s98, s98, 14336
    s_add_u32 s98, s98, s51
    s_add_u32 m0, s62, 98304
RL17:
    s_waitcnt lgkmcnt(0)
    s_barrier
    buffer_load_dwordx4 v2, s[32:35], s98 offen offset:0 sc1 lds
    buffer_load_dwordx4 v2, s[32:35], s98 offen offset:1024 sc1 lds
    buffer_load_dwordx4 v2, s[32:35], s98 offen offset:2048 sc1 lds
    s_mov_b32 exec_hi, 0
    buffer_load_dwordx4 v2, s[32:35], s98 offen offset:3072 sc1 lds
    s_mov_b32 exec_hi, -1
    s_add_u32 s100, s100, 1
    s_waitcnt vmcnt(0)
    s_barrier
    ds_read_b128 v[100:103], v10 offset:7168
    ds_read_b128 v[104:107], v10 offset:8192
    ds_read_b128 v[108:111], v10 offset:9216
    ds_read_b128 v[112:115], v10 offset:10240
    ds_read_b128 v[116:119], v10 offset:11264
    ds_read_b128 v[120:123], v10 offset:12288
    ds_read_b128 v[124:127], v11 offset:7168
    s_waitcnt lgkmcnt(4)
    v_max3_u32 v33, v100, v104, v108
    s_waitcnt lgkmcnt(2)
    v_max3_u32 v33, v112, v116, v33
    s_waitcnt lgkmcnt(0)
    v_max3_u32 v33, v120, v124, v33
    v_cmp_eq_u32 s[96:97], -1, v33
    s_cmp_lt_u32 s100, 20000
    s_cselect_b64 s[96:97], s[96:97], 0
    s_cmp_lg_u64 s[96:97], 0
    s_cbranch_scc1 RL17
    s_mov_b32 m0, s99
    s_branch BK17
CEND:
ol_24:
    s_mov_b64 s[96:97], vcc
    v_xor_b32 v40, 0xff800000, v56
    v_xor_b32 v41, 0xff800000, v57
    v_xor_b32 v42, 0xff800000, v58
    v_xor_b32 v43, 0xff800000, v59
    v_xor_b32 v44, 0xff800000, v60
    v_xor_b32 v45, 0xff800000, v61
    v_xor_b32 v46, 0xff800000, v62
    v_xor_b32 v47, 0xff800000, v63
    v_xor_b32 v48, 0xff800000, v64
    v_xor_b32 v49, 0xff800000, v65
    v_xor_b32 v50, 0xff800000, v66
    v_xor_b32 v51, 0xff800000, v67
    v_xor_b32 v52, 0xff800000, v68
    v_xor_b32 v53, 0xff800000, v69
    v_xor_b32 v54, 0xff800000, v70
    v_xor_b32 v55, 0xff800000, v71
    s_mov_b32 s17, 0
    v_mov_b32 v204, 0xff800000
    v_mov_b32 v172, 0
    v_mov_b32 v173, 0
    v_mov_b32 v174, 0
    v_mov_b32 v175, 0
    v_mov_b32 v176, 0
    v_mov_b32 v177, 0
    v_mov_b32 v178, 0
    v_mov_b32 v179, 0
    v_mov_b32 v180, 0
    v_mov_b32 v181, 0
    v_mov_b32 v182, 0
    v_mov_b32 v183, 0
    v_mov_b32 v184, 0
    v_mov_b32 v185, 0
    v_mov_b32 v186, 0
    v_mov_b32 v187, 0
fp_17:
    s_mov_b32 s16, 0
ft_18:
    s_add_u32 s58, s16, s8
    s_cmp_lt_u32 s58, 20480
    s_cselect_b32 s58, s54, 1
    s_cmp_eq_u32 s58, 0
    s_cbranch_scc1 fn_19
    v_add_u32 v205, s16, v13
    v_add_u32 v206, s16, v15
    ds_read_b128 v[128:131], v205 offset:0
    ds_read_b128 v[132:135], v205 offset:48
    ds_read_b64_tr_b16 v[136:137], v206 offset:0
    ds_read_b64_tr_b16 v[138:139], v206 offset:640
    ds_read_b64_tr_b16 v[140:141], v206 offset:1280
    ds_read_b64_tr_b16 v[142:143], v206 offset:1920
    s_waitcnt lgkmcnt(0)
    s_cmp_eq_u32 s16, 0
    s_cbranch_scc1 f1_20
    s_cmp_eq_u32 s16, 20480
    s_cbranch_scc1 f2_21
    v_mfma_f32_32x32x16_bf16 v[188:203], v[128:131], v[76:79], 0
    s_branch f3_22
f1_20:
    v_mfma_f32_32x32x16_bf16 v[188:203], v[128:131], v[76:79], v[56:71]
    s_branch f3_22
f2_21:
    v_mfma_f32_32x32x16_bf16 v[188:203], v[128:131], v[76:79], v[40:55]
f3_22:
    v_mfma_f32_32x32x16_bf16 v[188:203], v[132:135], v[34:37], v[188:203]
    s_nop 15
    s_cmp_eq_u32 s17, 1
    s_cbranch_scc1 fq_23
    v_max3_f32 v204, v188, v189, v204
    v_max3_f32 v204, v190, v191, v204
    v_max3_f32 v204, v192, v193, v204
    v_max3_f32 v204, v194, v195, v204
    v_max3_f32 v204, v196, v197, v204
    v_max3_f32 v204, v198, v199, v204
    v_max3_f32 v204, v200, v201, v204
    v_max3_f32 v204, v202, v203, v204
    s_branch fn_19
fq_23:
    v_sub_f32 v188, v188, v204
    v_sub_f32 v189, v189, v204
    v_sub_f32 v190, v190, v204
    v_sub_f32 v191, v191, v204
    v_sub_f32 v192, v192, v204
    v_sub_f32 v193, v193, v204
    v_sub_f32 v194, v194, v204
    v_sub_f32 v195, v195, v204
    v_sub_f32 v196, v196, v204
    v_sub_f32 v197, v197, v204
    v_sub_f32 v198, v198, v204
    v_sub_f32 v199, v199, v204
    v_sub_f32 v200, v200, v204
    v_sub_f32 v201, v201, v204
    v_sub_f32 v202, v202, v204
    v_sub_f32 v203, v203, v204
    v_exp_f32 v188, v188
    v_exp_f32 v189, v189
    v_exp_f32 v190, v190
    v_exp_f32 v191, v191
    v_exp_f32 v192, v192
    v_exp_f32 v193, v193
    v_exp_f32 v194, v194
    v_exp_f32 v195, v195
    v_exp_f32 v196, v196
    v_exp_f32 v197, v197
    v_exp_f32 v198, v198
    v_exp_f32 v199, v199
    v_exp_f32 v200, v200
    v_exp_f32 v201, v201
    v_exp_f32 v202, v202
    v_exp_f32 v203, v203
    v_cvt_pk_bf16_f32 v188, v188, v189
    v_cvt_pk_bf16_f32 v189, v190, v191
    v_cvt_pk_bf16_f32 v190, v192, v193
    v_cvt_pk_bf16_f32 v191, v194, v195
    v_cvt_pk_bf16_f32 v192, v196, v197
    v_cvt_pk_bf16_f32 v193, v198, v199
    v_cvt_pk_bf16_f32 v194, v200, v201
    v_cvt_pk_bf16_f32 v195, v202, v203
    v_mfma_f32_32x32x16_bf16 v[172:187], v[136:139], v[188:191], v[172:187]
    s_nop 0
    v_mfma_f32_32x32x16_bf16 v[172:187], v[140:143], v[192:195], v[172:187]
    s_nop 15
fn_19:
    s_add_u32 s16, s16, 2560
    s_cmp_le_u32 s16, 20480
    s_cbranch_scc1 ft_18
    v_mov_b32 v205, v204
    s_nop 1
    v_permlane32_swap_b32 v205, v204
    v_max_f32 v204, v205, v204
    s_add_u32 s17, s17, 1
    s_cmp_eq_u32 s17, 1
    s_cbranch_scc1 fp_17
    v_rcp_f32 v236, v184
    v_sub_f32 v237, 1.0, v97
    v_mul_f32 v236, v236, v237
    v_mul_f32 v172, v172, v236
    v_mul_f32 v173, v173, v236
    v_mul_f32 v174, v174, v236
    v_mul_f32 v175, v175, v236
    v_mul_f32 v176, v176, v236
    v_mul_f32 v177, v177, v236
    v_mul_f32 v178, v178, v236
    v_mul_f32 v179, v179, v236
    v_mul_f32 v182, v182, v236
    v_mul_f32 v183, v183, v236
    v_cvt_pk_bf16_f32 v184, v172, v173
    v_cvt_pk_bf16_f32 v185, v174, v175
    v_cvt_pk_bf16_f32 v186, v176, v177
    v_cvt_pk_bf16_f32 v187, v178, v179
    buffer_store_dwordx4 v[184:187], v0, s[32:35], s42 offen offset:0 sc1
    v_cvt_pk_bf16_f32 v147, v182, v183
    s_mov_b32 exec_hi, 0
    buffer_store_dwordx2 v[146:147], v8, s[32:35], s11 offen sc1
    s_mov_b32 exec_hi, -1
    s_waitcnt vmcnt(0)
    s_mov_b64 vcc, s[96:97]
    s_branch NOFB1
ol_32:
    v_xor_b32 v40, 0xff800000, v56
    v_xor_b32 v41, 0xff800000, v57
    v_xor_b32 v42, 0xff800000, v58
    v_xor_b32 v43, 0xff800000, v59
    v_xor_b32 v44, 0xff800000, v60
    v_xor_b32 v45, 0xff800000, v61
    v_xor_b32 v46, 0xff800000, v62
    v_xor_b32 v47, 0xff800000, v63
    v_xor_b32 v48, 0xff800000, v64
    v_xor_b32 v49, 0xff800000, v65
    v_xor_b32 v50, 0xff800000, v66
    v_xor_b32 v51, 0xff800000, v67
    v_xor_b32 v52, 0xff800000, v68
    v_xor_b32 v53, 0xff800000, v69
    v_xor_b32 v54, 0xff800000, v70
    v_xor_b32 v55, 0xff800000, v71
    s_mov_b32 s17, 0
    v_mov_b32 v204, 0xff800000
    v_mov_b32 v156, 0
    v_mov_b32 v157, 0
    v_mov_b32 v158, 0
    v_mov_b32 v159, 0
    v_mov_b32 v160, 0
    v_mov_b32 v161, 0
    v_mov_b32 v162, 0
    v_mov_b32 v163, 0
    v_mov_b32 v164, 0
    v_mov_b32 v165, 0
    v_mov_b32 v166, 0
    v_mov_b32 v167, 0
    v_mov_b32 v168, 0
    v_mov_b32 v169, 0
    v_mov_b32 v170, 0
    v_mov_b32 v171, 0
fp_25:
    s_mov_b32 s16, 0
ft_26:
    s_add_u32 s58, s16, s7
    s_cmp_lt_u32 s58, 20480
    s_cselect_b32 s58, s54, 1
    s_cmp_eq_u32 s58, 0
    s_cbranch_scc1 fn_27
    v_add_u32 v205, s16, v12
    v_add_u32 v206, s16, v14
    ds_read_b128 v[128:131], v205 offset:0
    ds_read_b128 v[132:135], v205 offset:48
    ds_read_b64_tr_b16 v[136:137], v206 offset:0
    ds_read_b64_tr_b16 v[138:139], v206 offset:640
    ds_read_b64_tr_b16 v[140:141], v206 offset:1280
    ds_read_b64_tr_b16 v[142:143], v206 offset:1920
    s_waitcnt lgkmcnt(0)
    s_cmp_eq_u32 s16, 0
    s_cbranch_scc1 f1_28
    s_cmp_eq_u32 s16, 20480
    s_cbranch_scc1 f2_29
    v_mfma_f32_32x32x16_bf16 v[188:203], v[128:131], v[72:75], 0
    s_branch f3_30
f1_28:
    v_mfma_f32_32x32x16_bf16 v[188:203], v[128:131], v[72:75], v[56:71]
    s_branch f3_30
f2_29:
    v_mfma_f32_32x32x16_bf16 v[188:203], v[128:131], v[72:75], v[40:55]
f3_30:
    v_mfma_f32_32x32x16_bf16 v[188:203], v[132:135], v[30:33], v[188:203]
    s_nop 15
    s_cmp_eq_u32 s17, 1
    s_cbranch_scc1 fq_31
    v_max3_f32 v204, v188, v189, v204
    v_max3_f32 v204, v190, v191, v204
    v_max3_f32 v204, v192, v193, v204
    v_max3_f32 v204, v194, v195, v204
    v_max3_f32 v204, v196, v197, v204
    v_max3_f32 v204, v198, v199, v204
    v_max3_f32 v204, v200, v201, v204
    v_max3_f32 v204, v202, v203, v204
    s_branch fn_27
fq_31:
    v_sub_f32 v188, v188, v204
    v_sub_f32 v189, v189, v204
    v_sub_f32 v190, v190, v204
    v_sub_f32 v191, v191, v204
    v_sub_f32 v192, v192, v204
    v_sub_f32 v193, v193, v204
    v_sub_f32 v194, v194, v204
    v_sub_f32 v195, v195, v204
    v_sub_f32 v196, v196, v204
    v_sub_f32 v197, v197, v204
    v_sub_f32 v198, v198, v204
    v_sub_f32 v199, v199, v204
    v_sub_f32 v200, v200, v204
    v_sub_f32 v201, v201, v204
    v_sub_f32 v202, v202, v204
    v_sub_f32 v203, v203, v204
    v_exp_f32 v188, v188
    v_exp_f32 v189, v189
    v_exp_f32 v190, v190
    v_exp_f32 v191, v191
    v_exp_f32 v192, v192
    v_exp_f32 v193, v193
    v_exp_f32 v194, v194
    v_exp_f32 v195, v195
    v_exp_f32 v196, v196
    v_exp_f32 v197, v197
    v_exp_f32 v198, v198
    v_exp_f32 v199, v199
    v_exp_f32 v200, v200
    v_exp_f32 v201, v201
    v_exp_f32 v202, v202
    v_exp_f32 v203, v203
    v_cvt_pk_bf16_f32 v188, v188, v189
    v_cvt_pk_bf16_f32 v189, v190, v191
    v_cvt_pk_bf16_f32 v190, v192, v193
    v_cvt_pk_bf16_f32 v191, v194, v195
    v_cvt_pk_bf16_f32 v192, v196, v197
    v_cvt_pk_bf16_f32 v193, v198, v199
    v_cvt_pk_bf16_f32 v194, v200, v201
    v_cvt_pk_bf16_f32 v195, v202, v203
    v_mfma_f32_32x32x16_bf16 v[156:171], v[136:139], v[188:191], v[156:171]
    s_nop 0
    v_mfma_f32_32x32x16_bf16 v[156:171], v[140:143], v[192:195], v[156:171]
    s_nop 15
fn_27:
    s_add_u32 s16, s16, 2560
    s_cmp_le_u32 s16, 20480
    s_cbranch_scc1 ft_26
    v_mov_b32 v205, v204
    s_nop 1
    v_permlane32_swap_b32 v205, v204
    v_max_f32 v204, v205, v204
    s_add_u32 s17, s17, 1
    s_cmp_eq_u32 s17, 1
    s_cbranch_scc1 fp_25
    s_branch NOFB0
.section .rodata,"a"
.p2align 6
.amdhsa_kernel gated_mix__linear_kernel_hedgehog__sliding_block__prompt_kernel
  .amdhsa_next_free_vgpr 512
  .amdhsa_next_free_sgpr 102
  .amdhsa_accum_offset 256
  .amdhsa_group_segment_fixed_size 0
  .amdhsa_kernarg_size 88
  .amdhsa_user_sgpr_count 2
  .amdhsa_user_sgpr_kernarg_segment_ptr 1
  .amdhsa_system_sgpr_workgroup_id_x 1
.end_amdhsa_kernel
```
